```python
import torch

def _softmax(x, axis=-1):
    return torch.softmax(x, dim=axis)
def _gelu(x):
    return torch.nn.functional.gelu(x, approximate="tanh")
def _silu(x):
    return torch.nn.functional.silu(x)
def _sigmoid(x):
    return torch.sigmoid(x)
def _layernorm(x, axis=-1, eps=1e-5):
    m = x.mean(dim=axis, keepdim=True)
    v = x.var(dim=axis, keepdim=True, unbiased=False)
    return (x - m) / torch.sqrt(v + eps)
def _scatter_add(tgt, idx, src, axis=0):
    return tgt.clone().index_add_(axis, idx, src)
def _segment_sum(src, seg, n):
    out = torch.zeros((n,) + src.shape[1:], dtype=src.dtype)
    return out.index_add_(0, seg, src)
def _pad(x, pw):
    flat = tuple(v for pair in reversed(pw) for v in pair)
    return torch.nn.functional.pad(x, flat)

kernel_name = 'concat_heads__mha_block_cached__gqa_block_cached__decode'

def setup_inputs():

    _w = (lambda a: (lambda t: t.to(torch.bfloat16) if t.is_floating_point() else t)(torch.as_tensor(a)))
    def _A_setup():
        B, Sq, D = 2, 1, 512
        H, Sk, Dh = 32, 16384, 128
        return {
            "x": _w((lambda *s: torch.randn(*s, dtype=torch.bfloat16) * 0.8)(B, Sq, D)),
            "k_cache": _w((lambda *s: torch.randn(*s, dtype=torch.bfloat16) * 0.8)(B, H, Sk, Dh)),
            "v_cache": _w((lambda *s: torch.randn(*s, dtype=torch.bfloat16) * 0.05)(B, H, Sk, Dh)),
            "wq": _w((lambda *s: torch.randn(*s, dtype=torch.bfloat16) * 0.8)(D, H * Dh) * (D ** -0.5)),
            "wo": _w((lambda *s: torch.randn(*s, dtype=torch.bfloat16) * 0.05)(H * Dh, D) * ((H * Dh) ** -0.5)),
        }
    _A_in = _A_setup()

    def _B_setup():
        B, Sq, D = 2, 1, 512
        Hq, Hkv, Sk, Dh = 32, 8, 16384, 128
        assert Hq % Hkv == 0, (Hq, Hkv)
        return {
            "x": _w((lambda *s: torch.randn(*s, dtype=torch.bfloat16) * 0.8)(B, Sq, D)),
            "k_cache": _w((lambda *s: torch.randn(*s, dtype=torch.bfloat16) * 0.8)(B, Hkv, Sk, Dh)),
            "v_cache": _w((lambda *s: torch.randn(*s, dtype=torch.bfloat16) * 0.05)(B, Hkv, Sk, Dh)),
            "wq": _w((lambda *s: torch.randn(*s, dtype=torch.bfloat16) * 0.8)(D, Hq * Dh) * (D ** -0.5)),
            "wo": _w((lambda *s: torch.randn(*s, dtype=torch.bfloat16) * 0.05)(Hq * Dh, D) * ((Hq * Dh) ** -0.5)),
        }
    _B_in = _B_setup()

    return {
        "A_x": _A_in["x"],
        "A_k_cache": _A_in["k_cache"],
        "A_v_cache": _A_in["v_cache"],
        "A_wq": _A_in["wq"],
        "A_wo": _A_in["wo"],
        "B_x": _B_in["x"],
        "B_k_cache": _B_in["k_cache"],
        "B_v_cache": _B_in["v_cache"],
        "B_wq": _B_in["wq"],
        "B_wo": _B_in["wo"],
    }

def reference(A_x, A_k_cache, A_v_cache, A_wq, A_wo, B_x, B_k_cache, B_v_cache, B_wq, B_wo):
    def _A_ref(x, k_cache, v_cache, wq, wo):
        B, Sq, D = x.shape
        H, Dh = 32, 128
        q = (lambda x, *d: x.permute(*d))((x @ wq).reshape(B, Sq, H, Dh), 0, 2, 1, 3)
        scores = torch.einsum("bhqd,bhkd->bhqk", q, k_cache) * (Dh ** -0.5)
        p = _softmax(scores, axis=-1)
        o = torch.einsum("bhqk,bhkd->bhqd", p, v_cache)
        return (lambda x, *d: x.permute(*d))(o, 0, 2, 1, 3).reshape(B, Sq, H * Dh) @ wo

    def _B_ref(x, k_cache, v_cache, wq, wo):
        B, Sq, D = x.shape
        Hq, Dh = 32, 128
        Hkv = k_cache.shape[1]
        rep = Hq // Hkv
        q = (lambda x, *d: x.permute(*d))((x @ wq).reshape(B, Sq, Hq, Dh), 0, 2, 1, 3)
        k = (lambda x, n, axis: torch.repeat_interleave(x, n, dim=axis))(k_cache, rep, axis=1)
        v = (lambda x, n, axis: torch.repeat_interleave(x, n, dim=axis))(v_cache, rep, axis=1)
        scores = torch.einsum("bhqd,bhkd->bhqk", q, k) * (Dh ** -0.5)
        p = _softmax(scores, axis=-1)
        o = torch.einsum("bhqk,bhkd->bhqd", p, v)
        return (lambda x, *d: x.permute(*d))(o, 0, 2, 1, 3).reshape(B, Sq, Hq * Dh) @ wo

    a = _A_ref(A_x, A_k_cache, A_v_cache, A_wq, A_wo)
    b = _B_ref(B_x, B_k_cache, B_v_cache, B_wq, B_wo)
    return torch.concatenate([a, b], axis=-1)
```

```asm
; @launch grid=(256,1,1) block=(512,1,1) lds=163840
.amdgcn_target "amdgcn-amd-amdhsa--gfx950"
.text
.globl concat_heads__mha_block_cached__gqa_block_cached__decode_kernel
.p2align 8
.type concat_heads__mha_block_cached__gqa_block_cached__decode_kernel,@function
concat_heads__mha_block_cached__gqa_block_cached__decode_kernel:
  s_cmp_ge_u32 s2, 256
  s_cbranch_scc1 L_end
  s_load_dwordx16 s[4:19], s[0:1], 0
  s_load_dwordx8 s[20:27], s[0:1], 64
  s_load_dwordx2 s[28:29], s[0:1], 96
  v_lshrrev_b32 v1, 6, v0
  s_and_b32 s30, s2, 7
  v_readfirstlane_b32 s3, v1
  s_lshr_b32 s31, s2, 3
  v_and_b32 v0, 63, v0
  s_lshr_b32 s33, s2, 6
  s_lshl2_add_u32 s32, s30, s33
  s_and_b32 s35, s2, 32
  s_add_u32 s35, s35, s32
  s_mov_b32 s42, 0x400000
  s_mov_b32 s43, 0x20000
  s_mov_b32 s39, s43
  s_cmp_ge_u32 s3, 4
  s_cbranch_scc1 L_helper
  v_lshlrev_b32 v3, 4, v0
  v_and_b32 v2, 48, v3
  v_and_b32 v4, 12, v0
  v_lshl_add_u32 v2, v4, 6, v2
  v_and_b32 v5, 48, v0
  v_lshl_add_u32 v36, v5, 2, v2
  s_and_b32 s41, s31, 3
  s_lshl2_add_u32 s41, s41, s3
  s_lshl_b32 s41, s41, 12
  s_mul_i32 s44, s35, 9
  s_lshl_b32 s44, s44, 27
  s_lshr_b32 s44, s44, 11
  s_mov_b32 s38, s42
  s_lshl_b32 s40, s35, 22
  s_or_b32 s40, s40, s41
  s_mov_b32 s49, s44
  s_waitcnt lgkmcnt(0)
  s_add_u32 s36, s6, s40
  s_addc_u32 s37, s7, 0
  buffer_load_dwordx4 v[128:131], v36, s[36:39], s44 offen offset:0 nt
  buffer_load_dwordx4 v[132:135], v36, s[36:39], s44 offen offset:1024 nt
  buffer_load_dwordx4 v[136:139], v36, s[36:39], s44 offen offset:2048 nt
  buffer_load_dwordx4 v[140:143], v36, s[36:39], s44 offen offset:3072 nt
  s_branch L_stream
L_helper:
  s_sub_u32 s33, s3, 4
  s_and_b32 s54, s31, 7
  s_and_b32 s49, s31, 3
  v_and_b32 v1, 15, v0
  v_lshrrev_b32 v2, 4, v0
  v_lshlrev_b32 v33, 10, v2
  v_lshl_add_u32 v33, v1, 4, v33
  s_cmp_eq_u32 s33, 0
  s_cbranch_scc1 L_h0a
  s_lshl_b32 s62, s32, 17
  s_cmp_eq_u32 s33, 1
  s_cbranch_scc1 L_h1a
  s_cmp_eq_u32 s33, 3
  s_cbranch_scc1 L_h3a
  v_mov_b32 v41, 2048
  v_mov_b32 v28, 0
  v_mov_b32 v29, 0
  v_mov_b32 v30, 0
  v_mov_b32 v31, 0
  ds_write_b128 v41, v[28:31]
  ds_write_b128 v41, v[28:31] offset:16
  s_lshl_b32 s63, s49, 3
  s_movk_i32 s36, 128
  s_and_b32 s50, s54, 4
  s_add_u32 s50, s50, s33
  s_cmp_lg_u32 s50, 2
  s_waitcnt lgkmcnt(0)
  s_mov_b32 s40, s12
  s_mov_b32 s41, s13
  s_cbranch_scc1 L_hz
L_pa:
  s_lshl_b32 s37, s63, 10
  s_add_u32 m0, s37, 16384
  s_lshl_b32 s50, s63, 12
  s_add_u32 s50, s50, s62
  buffer_load_dwordx4 v33, s[40:43], s50 offen  lds
  s_add_u32 m0, m0, 0x8000
  s_addk_i32 s50, 256
  buffer_load_dwordx4 v33, s[40:43], s50 offen  lds
  s_add_u32 m0, m0, 0x8000
  s_addk_i32 s50, 256
  buffer_load_dwordx4 v33, s[40:43], s50 offen  lds
  s_add_u32 m0, m0, 0x8000
  s_addk_i32 s50, 256
  buffer_load_dwordx4 v33, s[40:43], s50 offen  lds
  s_add_u32 s63, s63, 1
  s_and_b32 s63, s63, 31
  s_sub_u32 s36, s36, 4
  s_cmp_gt_u32 s36, 96
  s_cbranch_scc1 L_pa
  s_branch L_hz
L_h1a:
  s_lshl_b32 s50, s49, 8
  s_add_u32 s50, s50, s62
  s_cmp_lt_u32 s54, 4
  s_waitcnt lgkmcnt(0)
  s_mov_b32 s40, s22
  s_mov_b32 s41, s23
  s_cbranch_scc1 L_hz
  buffer_load_dwordx4 v[64:67], v33, s[40:43], s50 offen nt
  s_addk_i32 s50, 0x1000
  buffer_load_dwordx4 v[68:71], v33, s[40:43], s50 offen nt
  s_addk_i32 s50, 0x1000
  buffer_load_dwordx4 v[72:75], v33, s[40:43], s50 offen nt
  s_addk_i32 s50, 0x1000
  buffer_load_dwordx4 v[76:79], v33, s[40:43], s50 offen nt
  s_addk_i32 s50, 0x1000
  buffer_load_dwordx4 v[80:83], v33, s[40:43], s50 offen nt
  s_addk_i32 s50, 0x1000
  buffer_load_dwordx4 v[84:87], v33, s[40:43], s50 offen nt
  s_addk_i32 s50, 0x1000
  buffer_load_dwordx4 v[88:91], v33, s[40:43], s50 offen nt
  s_addk_i32 s50, 0x1000
  buffer_load_dwordx4 v[92:95], v33, s[40:43], s50 offen nt
  s_addk_i32 s50, 0x1000
  buffer_load_dwordx4 v[96:99], v33, s[40:43], s50 offen nt
  s_addk_i32 s50, 0x1000
  buffer_load_dwordx4 v[100:103], v33, s[40:43], s50 offen nt
  s_addk_i32 s50, 0x1000
  buffer_load_dwordx4 v[104:107], v33, s[40:43], s50 offen nt
  s_addk_i32 s50, 0x1000
  buffer_load_dwordx4 v[108:111], v33, s[40:43], s50 offen nt
  s_addk_i32 s50, 0x1000
  buffer_load_dwordx4 v[112:115], v33, s[40:43], s50 offen nt
  s_addk_i32 s50, 0x1000
  buffer_load_dwordx4 v[116:119], v33, s[40:43], s50 offen nt
  s_addk_i32 s50, 0x1000
  buffer_load_dwordx4 v[120:123], v33, s[40:43], s50 offen nt
  s_addk_i32 s50, 0x1000
  buffer_load_dwordx4 v[124:127], v33, s[40:43], s50 offen nt
  s_addk_i32 s50, 0x1000
  buffer_load_dwordx4 v[128:131], v33, s[40:43], s50 offen nt
  s_addk_i32 s50, 0x1000
  buffer_load_dwordx4 v[132:135], v33, s[40:43], s50 offen nt
  s_addk_i32 s50, 0x1000
  buffer_load_dwordx4 v[136:139], v33, s[40:43], s50 offen nt
  s_addk_i32 s50, 0x1000
  buffer_load_dwordx4 v[140:143], v33, s[40:43], s50 offen nt
  s_addk_i32 s50, 0x1000
  buffer_load_dwordx4 v[144:147], v33, s[40:43], s50 offen nt
  s_addk_i32 s50, 0x1000
  buffer_load_dwordx4 v[148:151], v33, s[40:43], s50 offen nt
  s_addk_i32 s50, 0x1000
  buffer_load_dwordx4 v[152:155], v33, s[40:43], s50 offen nt
  s_addk_i32 s50, 0x1000
  buffer_load_dwordx4 v[156:159], v33, s[40:43], s50 offen nt
  s_addk_i32 s50, 0x1000
  buffer_load_dwordx4 v[160:163], v33, s[40:43], s50 offen nt
  s_addk_i32 s50, 0x1000
  buffer_load_dwordx4 v[164:167], v33, s[40:43], s50 offen nt
  s_addk_i32 s50, 0x1000
  buffer_load_dwordx4 v[168:171], v33, s[40:43], s50 offen nt
  s_addk_i32 s50, 0x1000
  buffer_load_dwordx4 v[172:175], v33, s[40:43], s50 offen nt
  s_addk_i32 s50, 0x1000
  buffer_load_dwordx4 v[176:179], v33, s[40:43], s50 offen nt
  s_addk_i32 s50, 0x1000
  buffer_load_dwordx4 v[180:183], v33, s[40:43], s50 offen nt
  s_addk_i32 s50, 0x1000
  buffer_load_dwordx4 v[184:187], v33, s[40:43], s50 offen nt
  s_addk_i32 s50, 0x1000
  buffer_load_dwordx4 v[188:191], v33, s[40:43], s50 offen nt
  s_branch L_hz
L_h3a:
  s_getpc_b64 s[52:53]
L_pc157:
  s_sub_u32 s52, s52, L_pc157-concat_heads__mha_block_cached__gqa_block_cached__decode_kernel
  s_subb_u32 s53, s53, 0
  s_lshl_b32 s50, s31, 10
  v_lshl_add_u32 v42, v0, 4, s50
  s_mov_b32 s50, L_last-concat_heads__mha_block_cached__gqa_block_cached__decode_kernel-16
  v_min_u32 v42, s50, v42
  v_mov_b32 v43, s53
  v_add_co_u32 v42, vcc, s52, v42
  s_nop 1
  v_addc_co_u32 v43, vcc, 0, v43, vcc
  global_load_dwordx4 v[44:47], v[42:43], off
  s_waitcnt lgkmcnt(0)
  s_mov_b32 s40, s12
  s_mov_b32 s41, s13
L_hz:
  s_barrier
  s_branch L_hc
L_h0a:
  v_lshlrev_b32 v3, 18, v2
  v_lshl_add_u32 v3, v1, 4, v3
  v_and_b32 v35, 8, v0
  v_lshlrev_b32 v35, 7, v35
  v_lshl_add_u32 v35, v2, 6, v35
  s_lshl_b32 s50, s32, 8
  s_lshl_b32 s51, s49, 20
  s_add_u32 s50, s50, s51
  s_lshl_b32 s51, s49, 8
  s_movk_i32 s38, 2048
  s_cmp_lt_u32 s54, 4
  s_waitcnt lgkmcnt(0)
  s_cselect_b32 s36, s4, s14
  s_cselect_b32 s37, s5, s15
  s_cselect_b32 s40, s10, s20
  s_cselect_b32 s41, s11, s21
  buffer_load_dwordx4 v[8:11], v35, s[36:39], s51 offen offset:0
  buffer_load_dwordx4 v[12:15], v35, s[36:39], s51 offen offset:16
  buffer_load_dwordx4 v[16:19], v35, s[36:39], s51 offen offset:32
  buffer_load_dwordx4 v[20:23], v35, s[36:39], s51 offen offset:48
  buffer_load_dwordx4 v[64:67], v3, s[40:43], s50 offen nt
  s_addk_i32 s50, 0x2000
  buffer_load_dwordx4 v[68:71], v3, s[40:43], s50 offen nt
  s_addk_i32 s50, 0x2000
  buffer_load_dwordx4 v[72:75], v3, s[40:43], s50 offen nt
  s_addk_i32 s50, 0x2000
  buffer_load_dwordx4 v[76:79], v3, s[40:43], s50 offen nt
  s_addk_i32 s50, 0x2000
  buffer_load_dwordx4 v[80:83], v3, s[40:43], s50 offen nt
  s_addk_i32 s50, 0x2000
  buffer_load_dwordx4 v[84:87], v3, s[40:43], s50 offen nt
  s_addk_i32 s50, 0x2000
  buffer_load_dwordx4 v[88:91], v3, s[40:43], s50 offen nt
  s_addk_i32 s50, 0x2000
  buffer_load_dwordx4 v[92:95], v3, s[40:43], s50 offen nt
  s_addk_i32 s50, 0x2000
  buffer_load_dwordx4 v[96:99], v3, s[40:43], s50 offen nt
  s_addk_i32 s50, 0x2000
  buffer_load_dwordx4 v[100:103], v3, s[40:43], s50 offen nt
  s_addk_i32 s50, 0x2000
  buffer_load_dwordx4 v[104:107], v3, s[40:43], s50 offen nt
  s_addk_i32 s50, 0x2000
  buffer_load_dwordx4 v[108:111], v3, s[40:43], s50 offen nt
  s_addk_i32 s50, 0x2000
  buffer_load_dwordx4 v[112:115], v3, s[40:43], s50 offen nt
  s_addk_i32 s50, 0x2000
  buffer_load_dwordx4 v[116:119], v3, s[40:43], s50 offen nt
  s_addk_i32 s50, 0x2000
  buffer_load_dwordx4 v[120:123], v3, s[40:43], s50 offen nt
  s_addk_i32 s50, 0x2000
  buffer_load_dwordx4 v[124:127], v3, s[40:43], s50 offen nt
  s_addk_i32 s50, 0x2000
  buffer_load_dwordx4 v[128:131], v3, s[40:43], s50 offen nt
  s_addk_i32 s50, 0x2000
  buffer_load_dwordx4 v[132:135], v3, s[40:43], s50 offen nt
  s_addk_i32 s50, 0x2000
  buffer_load_dwordx4 v[136:139], v3, s[40:43], s50 offen nt
  s_addk_i32 s50, 0x2000
  buffer_load_dwordx4 v[140:143], v3, s[40:43], s50 offen nt
  s_addk_i32 s50, 0x2000
  buffer_load_dwordx4 v[144:147], v3, s[40:43], s50 offen nt
  s_addk_i32 s50, 0x2000
  buffer_load_dwordx4 v[148:151], v3, s[40:43], s50 offen nt
  s_addk_i32 s50, 0x2000
  buffer_load_dwordx4 v[152:155], v3, s[40:43], s50 offen nt
  s_addk_i32 s50, 0x2000
  buffer_load_dwordx4 v[156:159], v3, s[40:43], s50 offen nt
  s_addk_i32 s50, 0x2000
  buffer_load_dwordx4 v[160:163], v3, s[40:43], s50 offen nt
  s_addk_i32 s50, 0x2000
  buffer_load_dwordx4 v[164:167], v3, s[40:43], s50 offen nt
  s_addk_i32 s50, 0x2000
  buffer_load_dwordx4 v[168:171], v3, s[40:43], s50 offen nt
  s_addk_i32 s50, 0x2000
  buffer_load_dwordx4 v[172:175], v3, s[40:43], s50 offen nt
  s_addk_i32 s50, 0x2000
  buffer_load_dwordx4 v[176:179], v3, s[40:43], s50 offen nt
  s_addk_i32 s50, 0x2000
  buffer_load_dwordx4 v[180:183], v3, s[40:43], s50 offen nt
  s_addk_i32 s50, 0x2000
  buffer_load_dwordx4 v[184:187], v3, s[40:43], s50 offen nt
  s_addk_i32 s50, 0x2000
  buffer_load_dwordx4 v[188:191], v3, s[40:43], s50 offen nt
  s_add_u32 s52, s28, 0x100000
  s_addc_u32 s53, s29, 0
  s_load_dword s55, s[52:53], 0x0
  s_load_dword s84, s[52:53], 0x1100
  s_load_dword s85, s[52:53], 0x2200
  s_load_dword s90, s[52:53], 0x3300
  s_load_dword s91, s[52:53], 0x4400
  s_load_dword s92, s[52:53], 0x5500
  s_load_dword s93, s[52:53], 0x6600
  s_load_dword s95, s[52:53], 0x7700
L_hc:
  v_mov_b32 v41, 2048
  v_bfe_u32 v34, v0, 3, 1
  v_and_b32 v24, 1, v0
  v_lshlrev_b32 v24, 4, v24
  v_mov_b32 v25, 0xffff
  v_lshlrev_b32 v24, v24, v25
  v_bfe_u32 v25, v0, 1, 2
  v_cmp_eq_u32 vcc, 0, v25
  s_nop 1
  v_cndmask_b32 v4, 0, v24, vcc
  v_cmp_eq_u32 vcc, 1, v25
  s_nop 1
  v_cndmask_b32 v5, 0, v24, vcc
  v_cmp_eq_u32 vcc, 2, v25
  s_nop 1
  v_cndmask_b32 v6, 0, v24, vcc
  v_cmp_eq_u32 vcc, 3, v25
  s_nop 1
  v_cndmask_b32 v7, 0, v24, vcc
  v_lshlrev_b32 v40, 4, v0
  v_mov_b32 v60, 0
  s_add_u32 s44, s28, 0x0
  s_addc_u32 s45, s29, 0
  s_mov_b32 s46, s42
  s_mov_b32 s47, s43
  s_mov_b32 s56, 0x7060500
  s_mov_b32 s57, 0x7060501
  s_mov_b32 s58, 0x7060502
  s_mov_b32 s59, 0x7060503
  s_mov_b32 s76, 0x0c0c0400
  s_mov_b32 s77, 0x0c040100
  s_mov_b32 s78, 0x04020100
  s_movk_i32 s94, 0xff00
  s_cmp_lg_u32 s33, 0
  s_cbranch_scc1 L_hb
  s_waitcnt lgkmcnt(0)
  s_add_u32 s51, s55, 0x04030201
  s_sub_u32 s84, s84, s55
  s_mul_i32 s84, s84, 0xafd9d5ab
  s_add_u32 s51, s51, s84
  s_sub_u32 s85, s85, s55
  s_mul_i32 s85, s85, 0x41166b6d
  s_add_u32 s51, s51, s85
  s_sub_u32 s90, s90, s55
  s_mul_i32 s90, s90, 0xfc540c27
  s_add_u32 s51, s51, s90
  s_sub_u32 s91, s91, s55
  s_mul_i32 s91, s91, 0x8bf98909
  s_add_u32 s51, s51, s91
  s_sub_u32 s92, s92, s55
  s_mul_i32 s92, s92, 0x9a6db343
  s_add_u32 s51, s51, s92
  s_sub_u32 s93, s93, s55
  s_mul_i32 s93, s93, 0xd2175c05
  s_add_u32 s51, s51, s93
  s_sub_u32 s95, s95, s55
  s_mul_i32 s95, s95, 0xdd5d547f
  s_add_u32 s51, s51, s95
  s_mov_b32 s55, s51
  v_mov_b32 v63, s55
  v_mov_b32 v62, 1
  s_mov_b32 s52, 0x01000100
  s_mov_b32 s53, 0x03020302
  s_waitcnt vmcnt(32)
  v_perm_b32 v32, v8, v8, s52
  v_and_b32 v24, v32, v4
  v_and_b32 v25, v32, v5
  v_and_b32 v26, v32, v6
  v_and_b32 v27, v32, v7
  s_waitcnt vmcnt(31)
  s_nop 0
  v_mfma_f32_16x16x32_bf16 v[56:59], v[24:27], v[64:67], 0
  v_perm_b32 v32, v8, v8, s53
  v_and_b32 v24, v32, v4
  v_and_b32 v25, v32, v5
  v_and_b32 v26, v32, v6
  v_and_b32 v27, v32, v7
  s_waitcnt vmcnt(30)
  s_nop 0
  v_mfma_f32_16x16x32_bf16 v[56:59], v[24:27], v[68:71], v[56:59]
  v_perm_b32 v32, v9, v9, s52
  v_and_b32 v24, v32, v4
  v_and_b32 v25, v32, v5
  v_and_b32 v26, v32, v6
  v_and_b32 v27, v32, v7
  s_waitcnt vmcnt(29)
  s_nop 0
  v_mfma_f32_16x16x32_bf16 v[56:59], v[24:27], v[72:75], v[56:59]
  v_perm_b32 v32, v9, v9, s53
  v_and_b32 v24, v32, v4
  v_and_b32 v25, v32, v5
  v_and_b32 v26, v32, v6
  v_and_b32 v27, v32, v7
  s_waitcnt vmcnt(28)
  s_nop 0
  v_mfma_f32_16x16x32_bf16 v[56:59], v[24:27], v[76:79], v[56:59]
  v_perm_b32 v32, v10, v10, s52
  v_and_b32 v24, v32, v4
  v_and_b32 v25, v32, v5
  v_and_b32 v26, v32, v6
  v_and_b32 v27, v32, v7
  s_waitcnt vmcnt(27)
  s_nop 0
  v_mfma_f32_16x16x32_bf16 v[56:59], v[24:27], v[80:83], v[56:59]
  v_perm_b32 v32, v10, v10, s53
  v_and_b32 v24, v32, v4
  v_and_b32 v25, v32, v5
  v_and_b32 v26, v32, v6
  v_and_b32 v27, v32, v7
  s_waitcnt vmcnt(26)
  s_nop 0
  v_mfma_f32_16x16x32_bf16 v[56:59], v[24:27], v[84:87], v[56:59]
  v_perm_b32 v32, v11, v11, s52
  v_and_b32 v24, v32, v4
  v_and_b32 v25, v32, v5
  v_and_b32 v26, v32, v6
  v_and_b32 v27, v32, v7
  s_waitcnt vmcnt(25)
  s_nop 0
  v_mfma_f32_16x16x32_bf16 v[56:59], v[24:27], v[88:91], v[56:59]
  v_perm_b32 v32, v11, v11, s53
  v_and_b32 v24, v32, v4
  v_and_b32 v25, v32, v5
  v_and_b32 v26, v32, v6
  v_and_b32 v27, v32, v7
  s_waitcnt vmcnt(24)
  s_nop 0
  v_mfma_f32_16x16x32_bf16 v[56:59], v[24:27], v[92:95], v[56:59]
  v_perm_b32 v32, v12, v12, s52
  v_and_b32 v24, v32, v4
  v_and_b32 v25, v32, v5
  v_and_b32 v26, v32, v6
  v_and_b32 v27, v32, v7
  s_waitcnt vmcnt(23)
  s_nop 0
  v_mfma_f32_16x16x32_bf16 v[56:59], v[24:27], v[96:99], v[56:59]
  v_perm_b32 v32, v12, v12, s53
  v_and_b32 v24, v32, v4
  v_and_b32 v25, v32, v5
  v_and_b32 v26, v32, v6
  v_and_b32 v27, v32, v7
  s_waitcnt vmcnt(22)
  s_nop 0
  v_mfma_f32_16x16x32_bf16 v[56:59], v[24:27], v[100:103], v[56:59]
  v_perm_b32 v32, v13, v13, s52
  v_and_b32 v24, v32, v4
  v_and_b32 v25, v32, v5
  v_and_b32 v26, v32, v6
  v_and_b32 v27, v32, v7
  s_waitcnt vmcnt(21)
  s_nop 0
  v_mfma_f32_16x16x32_bf16 v[56:59], v[24:27], v[104:107], v[56:59]
  v_perm_b32 v32, v13, v13, s53
  v_and_b32 v24, v32, v4
  v_and_b32 v25, v32, v5
  v_and_b32 v26, v32, v6
  v_and_b32 v27, v32, v7
  s_waitcnt vmcnt(20)
  s_nop 0
  v_mfma_f32_16x16x32_bf16 v[56:59], v[24:27], v[108:111], v[56:59]
  v_perm_b32 v32, v14, v14, s52
  v_and_b32 v24, v32, v4
  v_and_b32 v25, v32, v5
  v_and_b32 v26, v32, v6
  v_and_b32 v27, v32, v7
  s_waitcnt vmcnt(19)
  s_nop 0
  v_mfma_f32_16x16x32_bf16 v[56:59], v[24:27], v[112:115], v[56:59]
  v_perm_b32 v32, v14, v14, s53
  v_and_b32 v24, v32, v4
  v_and_b32 v25, v32, v5
  v_and_b32 v26, v32, v6
  v_and_b32 v27, v32, v7
  s_waitcnt vmcnt(18)
  s_nop 0
  v_mfma_f32_16x16x32_bf16 v[56:59], v[24:27], v[116:119], v[56:59]
  v_perm_b32 v32, v15, v15, s52
  v_and_b32 v24, v32, v4
  v_and_b32 v25, v32, v5
  v_and_b32 v26, v32, v6
  v_and_b32 v27, v32, v7
  s_waitcnt vmcnt(17)
  s_nop 0
  v_mfma_f32_16x16x32_bf16 v[56:59], v[24:27], v[120:123], v[56:59]
  v_perm_b32 v32, v15, v15, s53
  v_and_b32 v24, v32, v4
  v_and_b32 v25, v32, v5
  v_and_b32 v26, v32, v6
  v_and_b32 v27, v32, v7
  s_waitcnt vmcnt(16)
  s_nop 0
  v_mfma_f32_16x16x32_bf16 v[56:59], v[24:27], v[124:127], v[56:59]
  v_perm_b32 v32, v16, v16, s52
  v_and_b32 v24, v32, v4
  v_and_b32 v25, v32, v5
  v_and_b32 v26, v32, v6
  v_and_b32 v27, v32, v7
  s_waitcnt vmcnt(15)
  s_nop 0
  v_mfma_f32_16x16x32_bf16 v[56:59], v[24:27], v[128:131], v[56:59]
  v_perm_b32 v32, v16, v16, s53
  v_and_b32 v24, v32, v4
  v_and_b32 v25, v32, v5
  v_and_b32 v26, v32, v6
  v_and_b32 v27, v32, v7
  s_waitcnt vmcnt(14)
  s_nop 0
  v_mfma_f32_16x16x32_bf16 v[56:59], v[24:27], v[132:135], v[56:59]
  v_perm_b32 v32, v17, v17, s52
  v_and_b32 v24, v32, v4
  v_and_b32 v25, v32, v5
  v_and_b32 v26, v32, v6
  v_and_b32 v27, v32, v7
  s_waitcnt vmcnt(13)
  s_nop 0
  v_mfma_f32_16x16x32_bf16 v[56:59], v[24:27], v[136:139], v[56:59]
  v_perm_b32 v32, v17, v17, s53
  v_and_b32 v24, v32, v4
  v_and_b32 v25, v32, v5
  v_and_b32 v26, v32, v6
  v_and_b32 v27, v32, v7
  s_waitcnt vmcnt(12)
  s_nop 0
  v_mfma_f32_16x16x32_bf16 v[56:59], v[24:27], v[140:143], v[56:59]
  v_perm_b32 v32, v18, v18, s52
  v_and_b32 v24, v32, v4
  v_and_b32 v25, v32, v5
  v_and_b32 v26, v32, v6
  v_and_b32 v27, v32, v7
  s_waitcnt vmcnt(11)
  s_nop 0
  v_mfma_f32_16x16x32_bf16 v[56:59], v[24:27], v[144:147], v[56:59]
  v_perm_b32 v32, v18, v18, s53
  v_and_b32 v24, v32, v4
  v_and_b32 v25, v32, v5
  v_and_b32 v26, v32, v6
  v_and_b32 v27, v32, v7
  s_waitcnt vmcnt(10)
  s_nop 0
  v_mfma_f32_16x16x32_bf16 v[56:59], v[24:27], v[148:151], v[56:59]
  v_perm_b32 v32, v19, v19, s52
  v_and_b32 v24, v32, v4
  v_and_b32 v25, v32, v5
  v_and_b32 v26, v32, v6
  v_and_b32 v27, v32, v7
  s_waitcnt vmcnt(9)
  s_nop 0
  v_mfma_f32_16x16x32_bf16 v[56:59], v[24:27], v[152:155], v[56:59]
  v_perm_b32 v32, v19, v19, s53
  v_and_b32 v24, v32, v4
  v_and_b32 v25, v32, v5
  v_and_b32 v26, v32, v6
  v_and_b32 v27, v32, v7
  s_waitcnt vmcnt(8)
  s_nop 0
  v_mfma_f32_16x16x32_bf16 v[56:59], v[24:27], v[156:159], v[56:59]
  v_perm_b32 v32, v20, v20, s52
  v_and_b32 v24, v32, v4
  v_and_b32 v25, v32, v5
  v_and_b32 v26, v32, v6
  v_and_b32 v27, v32, v7
  s_waitcnt vmcnt(7)
  s_nop 0
  v_mfma_f32_16x16x32_bf16 v[56:59], v[24:27], v[160:163], v[56:59]
  s_barrier
  v_perm_b32 v32, v20, v20, s53
  v_and_b32 v24, v32, v4
  v_and_b32 v25, v32, v5
  v_and_b32 v26, v32, v6
  v_and_b32 v27, v32, v7
  s_waitcnt vmcnt(6)
  s_nop 0
  v_mfma_f32_16x16x32_bf16 v[56:59], v[24:27], v[164:167], v[56:59]
  v_perm_b32 v32, v21, v21, s52
  v_and_b32 v24, v32, v4
  v_and_b32 v25, v32, v5
  v_and_b32 v26, v32, v6
  v_and_b32 v27, v32, v7
  s_waitcnt vmcnt(5)
  s_nop 0
  v_mfma_f32_16x16x32_bf16 v[56:59], v[24:27], v[168:171], v[56:59]
  v_perm_b32 v32, v21, v21, s53
  v_and_b32 v24, v32, v4
  v_and_b32 v25, v32, v5
  v_and_b32 v26, v32, v6
  v_and_b32 v27, v32, v7
  s_waitcnt vmcnt(4)
  s_nop 0
  v_mfma_f32_16x16x32_bf16 v[56:59], v[24:27], v[172:175], v[56:59]
  v_perm_b32 v32, v22, v22, s52
  v_and_b32 v24, v32, v4
  v_and_b32 v25, v32, v5
  v_and_b32 v26, v32, v6
  v_and_b32 v27, v32, v7
  s_waitcnt vmcnt(3)
  s_nop 0
  v_mfma_f32_16x16x32_bf16 v[56:59], v[24:27], v[176:179], v[56:59]
  v_perm_b32 v32, v22, v22, s53
  v_and_b32 v24, v32, v4
  v_and_b32 v25, v32, v5
  v_and_b32 v26, v32, v6
  v_and_b32 v27, v32, v7
  s_waitcnt vmcnt(2)
  s_nop 0
  v_mfma_f32_16x16x32_bf16 v[56:59], v[24:27], v[180:183], v[56:59]
  v_perm_b32 v32, v23, v23, s52
  v_and_b32 v24, v32, v4
  v_and_b32 v25, v32, v5
  v_and_b32 v26, v32, v6
  v_and_b32 v27, v32, v7
  s_waitcnt vmcnt(1)
  s_nop 0
  v_mfma_f32_16x16x32_bf16 v[56:59], v[24:27], v[184:187], v[56:59]
  v_perm_b32 v32, v23, v23, s53
  v_and_b32 v24, v32, v4
  v_and_b32 v25, v32, v5
  v_and_b32 v26, v32, v6
  v_and_b32 v27, v32, v7
  s_waitcnt vmcnt(0)
  s_nop 0
  v_mfma_f32_16x16x32_bf16 v[56:59], v[24:27], v[188:191], v[56:59]
  s_lshl_b32 s52, s32, 13
  s_add_u32 s52, s52, 0x300000
  s_lshl_b32 s51, s54, 10
  s_add_u32 s51, s51, s52
  s_nop 3
  v_perm_b32 v56, v56, v63, s56
  v_perm_b32 v57, v57, v63, s57
  v_perm_b32 v58, v58, v63, s58
  v_perm_b32 v59, v59, v63, s59
  buffer_store_dwordx4 v[56:59], v40, s[44:47], s51 offen sc1
  v_and_b32 v42, 31, v0
  v_lshlrev_b32 v42, 4, v42
  v_lshrrev_b32 v24, 5, v0
  v_lshl_add_u32 v42, v24, 10, v42
  v_lshlrev_b32 v43, 4, v1
  v_lshl_add_u32 v43, v24, 2, v43
  v_and_b32 v24, 1, v2
  v_lshl_add_u32 v43, v24, 3, v43
  s_and_b32 s51, s2, 32
  s_lshl4_add_u32 s52, s51, s52
  s_waitcnt vmcnt(0)
  s_mov_b32 s50, 16777216
L_p158:
  ds_read_b32 v24, v41 offset:28
  s_waitcnt lgkmcnt(0)
  v_readfirstlane_b32 s51, v24
  s_sub_u32 s50, s50, 1
  s_cbranch_scc1 L_pd158
  s_cmp_ge_u32 s51, 1
  s_cbranch_scc1 L_pd158
  s_sleep 2
  s_branch L_p158
L_pd158:
  s_mov_b32 s79, 1048576
L_g159:
  buffer_load_dwordx4 v[8:11], v42, s[44:47], s52 offen offset:0 sc1
  buffer_load_dwordx4 v[12:15], v42, s[44:47], s52 offen offset:2048 sc1
  s_waitcnt vmcnt(1)
  v_perm_b32 v24, v9, v8, s76
  v_perm_b32 v24, v10, v24, s77
  v_perm_b32 v24, v11, v24, s78
  v_and_b32 v8, s94, v8
  v_and_b32 v9, s94, v9
  v_and_b32 v10, s94, v10
  v_and_b32 v11, s94, v11
  s_waitcnt vmcnt(0)
  v_perm_b32 v25, v13, v12, s76
  v_perm_b32 v25, v14, v25, s77
  v_perm_b32 v25, v15, v25, s78
  v_and_b32 v12, s94, v12
  v_and_b32 v13, s94, v13
  v_and_b32 v14, s94, v14
  v_and_b32 v15, s94, v15
  v_cmpx_eq_u32 vcc, s55, v24
  v_cmpx_eq_u32 vcc, s55, v25
  s_not_b64 s[80:81], vcc
  s_mov_b64 exec, -1
  s_cbranch_scc0 L_gd159
  s_sub_u32 s79, s79, 1
  s_cbranch_scc1 L_gd159
  s_sleep 8
  s_branch L_g159
L_gd159:
  v_add_f32 v8, v8, v12
  v_add_f32 v9, v9, v13
  v_add_f32 v10, v10, v14
  v_add_f32 v11, v11, v15
  s_nop 0
  v_permlane32_swap_b32 v8, v10
  v_permlane32_swap_b32 v9, v11
  v_add_f32 v8, v8, v10
  v_add_f32 v9, v9, v11
  v_cvt_pk_bf16_f32 v8, v8, v9
  ds_write_b32 v43, v8 offset:0
  ds_write_b64 v41, v[62:63] offset:16
  s_branch L_htiles
L_stream:
  s_mov_b32 s45, 0x1f0000
  v_mov_b32 v2, v36
  s_lshl_b32 s50, s3, 12
  s_add_u32 s95, s50, 147456
  v_add_u32 v38, s95, v5
  v_add_u32 v37, v38, v4
  s_add_u32 s95, s50, 81920
  v_and_b32 v39, 60, v0
  v_lshl_add_u32 v39, v39, 2, s95
  v_and_b32 v6, 1, v0
  v_lshlrev_b32 v6, 4, v6
  v_mov_b32 v7, 0xffff
  v_lshlrev_b32 v6, v6, v7
  v_and_b32 v7, 2, v0
  v_cmp_eq_u32 vcc, 0, v7
  s_mov_b32 s48, 0x3e0293ee
  v_mov_b32 v8, 0xff800000
  v_cndmask_b32 v4, 0, v6, vcc
  v_xor_b32 v5, v4, v6
  v_mov_b32 v10, 0
  v_mov_b32 v11, v8
  v_mov_b32 v13, 0
  v_mov_b32 v40, 0
  v_mov_b32 v41, 0
  v_mov_b32 v42, 0
  v_mov_b32 v43, 0
  v_mov_b32 v44, 0
  v_mov_b32 v45, 0
  v_mov_b32 v46, 0
  v_mov_b32 v47, 0
  v_mov_b32 v48, 0
  v_mov_b32 v49, 0
  v_mov_b32 v50, 0
  v_mov_b32 v51, 0
  v_mov_b32 v52, 0
  v_mov_b32 v53, 0
  v_mov_b32 v54, 0
  v_mov_b32 v55, 0
  v_and_b32 v6, 0xff, v2
  v_bfe_u32 v7, v0, 2, 2
  v_cmp_eq_u32 s[84:85], 0, v7
  v_cmp_eq_u32 s[86:87], 1, v7
  v_cmp_eq_u32 s[88:89], 2, v7
  v_cmp_eq_u32 s[90:91], 3, v7
  s_mov_b32 s56, 0x7060500
  s_mov_b32 s57, 0x7060501
  s_mov_b32 s58, 0x7060502
  s_mov_b32 s59, 0x7060503
  s_mov_b32 s76, 0x0c0c0400
  s_mov_b32 s77, 0x0c040100
  s_mov_b32 s78, 0x04020100
  s_movk_i32 s94, 0xff00
  v_mov_b32 v14, 2048
  v_mov_b32 v15, 1
  v_mov_b32 v90, 0
  v_mov_b32 v91, 0xffffff40
  s_mov_b32 s33, 0
  s_movk_i32 s34, -256
  s_barrier
  s_xor_b32 s44, s44, 0x200000
  buffer_load_dwordx4 v[144:147], v36, s[36:39], s44 offen offset:0 nt
  s_waitcnt vmcnt(4)
  buffer_load_dwordx4 v[148:151], v36, s[36:39], s44 offen offset:1024 nt
  s_waitcnt vmcnt(4)
  buffer_load_dwordx4 v[152:155], v36, s[36:39], s44 offen offset:2048 nt
  s_waitcnt vmcnt(4)
  buffer_load_dwordx4 v[156:159], v36, s[36:39], s44 offen offset:3072 nt
  s_sub_u32 s44, s44, s45
  s_and_b32 s44, s44, s45
  s_waitcnt vmcnt(4)
  buffer_load_dwordx4 v[160:163], v36, s[36:39], s44 offen offset:0 nt
  s_waitcnt vmcnt(4)
  buffer_load_dwordx4 v[164:167], v36, s[36:39], s44 offen offset:1024 nt
  s_waitcnt vmcnt(4)
  buffer_load_dwordx4 v[168:171], v36, s[36:39], s44 offen offset:2048 nt
  s_waitcnt vmcnt(4)
  buffer_load_dwordx4 v[172:175], v36, s[36:39], s44 offen offset:3072 nt
  s_waitcnt vmcnt(4)
  s_xor_b32 s44, s44, 0x200000
  buffer_load_dwordx4 v[176:179], v36, s[36:39], s44 offen offset:0 nt
  s_waitcnt vmcnt(4)
  buffer_load_dwordx4 v[180:183], v36, s[36:39], s44 offen offset:1024 nt
  s_waitcnt vmcnt(4)
  buffer_load_dwordx4 v[184:187], v36, s[36:39], s44 offen offset:2048 nt
  ds_write_b32 v14, v15 offset:28
  s_waitcnt vmcnt(4)
  buffer_load_dwordx4 v[188:191], v36, s[36:39], s44 offen offset:3072 nt
  s_sub_u32 s44, s44, s45
  s_and_b32 s44, s44, s45
  s_waitcnt vmcnt(4)
  buffer_load_dwordx4 v[192:195], v36, s[36:39], s44 offen offset:0 nt
  s_waitcnt vmcnt(4)
  buffer_load_dwordx4 v[196:199], v36, s[36:39], s44 offen offset:1024 nt
  s_waitcnt vmcnt(4)
  buffer_load_dwordx4 v[200:203], v36, s[36:39], s44 offen offset:2048 nt
  s_waitcnt vmcnt(4)
  buffer_load_dwordx4 v[204:207], v36, s[36:39], s44 offen offset:3072 nt
  s_waitcnt vmcnt(4)
  s_xor_b32 s44, s44, 0x200000
  buffer_load_dwordx4 v[208:211], v36, s[36:39], s44 offen offset:0 nt
  s_waitcnt vmcnt(4)
  buffer_load_dwordx4 v[212:215], v36, s[36:39], s44 offen offset:1024 nt
  s_waitcnt vmcnt(4)
  buffer_load_dwordx4 v[216:219], v36, s[36:39], s44 offen offset:2048 nt
  s_waitcnt vmcnt(4)
  buffer_load_dwordx4 v[220:223], v36, s[36:39], s44 offen offset:3072 nt
  s_sub_u32 s44, s44, s45
  s_and_b32 s44, s44, s45
  s_waitcnt vmcnt(4)
  buffer_load_dwordx4 v[224:227], v36, s[36:39], s44 offen offset:0 nt
  s_waitcnt vmcnt(4)
  buffer_load_dwordx4 v[228:231], v36, s[36:39], s44 offen offset:1024 nt
  s_waitcnt vmcnt(4)
  buffer_load_dwordx4 v[232:235], v36, s[36:39], s44 offen offset:2048 nt
  s_waitcnt vmcnt(4)
  buffer_load_dwordx4 v[236:239], v36, s[36:39], s44 offen offset:3072 nt
  s_waitcnt vmcnt(4)
  s_xor_b32 s44, s44, 0x200000
  buffer_load_dwordx4 v[240:243], v36, s[36:39], s44 offen offset:0 nt
  s_waitcnt vmcnt(4)
  buffer_load_dwordx4 v[244:247], v36, s[36:39], s44 offen offset:1024 nt
  s_waitcnt vmcnt(4)
  buffer_load_dwordx4 v[248:251], v36, s[36:39], s44 offen offset:2048 nt
  s_waitcnt vmcnt(4)
  buffer_load_dwordx4 v[252:255], v36, s[36:39], s44 offen offset:3072 nt
  s_sub_u32 s44, s44, s45
  s_and_b32 s44, s44, s45
  s_mov_b32 s50, 33554432
L_wqa:
  ds_read_b64 v[108:109], v14 offset:16
  ds_read_b128 v[104:107], v6 offset:0
  s_waitcnt lgkmcnt(0)
  v_readfirstlane_b32 s51, v108
  v_readfirstlane_b32 s55, v109
  s_sub_u32 s50, s50, 1
  s_cbranch_scc1 L_wqa_done
  s_cmp_eq_u32 s51, 0
  s_cbranch_scc1 L_wqa
L_wqa_done:
  v_cndmask_b32 v16, 0, v104, s[84:85]
  v_cndmask_b32 v17, 0, v105, s[84:85]
  v_cndmask_b32 v18, 0, v106, s[84:85]
  v_cndmask_b32 v19, 0, v107, s[84:85]
  v_cndmask_b32 v20, 0, v104, s[86:87]
  v_cndmask_b32 v21, 0, v105, s[86:87]
  v_cndmask_b32 v22, 0, v106, s[86:87]
  v_cndmask_b32 v23, 0, v107, s[86:87]
  v_cndmask_b32 v24, 0, v104, s[88:89]
  v_cndmask_b32 v25, 0, v105, s[88:89]
  v_cndmask_b32 v26, 0, v106, s[88:89]
  v_cndmask_b32 v27, 0, v107, s[88:89]
  v_cndmask_b32 v28, 0, v104, s[90:91]
  v_cndmask_b32 v29, 0, v105, s[90:91]
  v_cndmask_b32 v30, 0, v106, s[90:91]
  v_cndmask_b32 v31, 0, v107, s[90:91]
  s_mov_b32 s47, 8
  v_mov_b32 v1, v37
L_km:
  s_cmp_lg_u32 s47, 1
  s_cbranch_scc1 L_km_go
  s_lshr_b32 s52, s31, 4
  s_lshl3_add_u32 s50, s52, s30
  s_lshl_b32 s51, s50, 22
  s_or_b32 s41, s41, s51
  s_bfe_u32 s51, s31, 0x10002
  s_lshl_b32 s51, s51, 16
  s_or_b32 s41, s41, s51
  s_bfe_u32 s51, s31, 0x10003
  s_lshl_b32 s51, s51, 19
  s_or_b32 s41, s41, s51
  s_add_u32 s36, s16, s41
  s_addc_u32 s37, s17, 0
  s_mul_i32 s50, s50, 1
  s_bfe_u32 s44, s50, 0x10000
  s_lshl_b32 s44, s44, 17
  s_bfe_u32 s51, s50, 0x10001
  s_lshl_b32 s51, s51, 18
  s_or_b32 s44, s44, s51
  s_bfe_u32 s51, s50, 0x10002
  s_lshl_b32 s51, s51, 20
  s_or_b32 s44, s44, s51
  s_mov_b32 s45, 0x160000
L_km_go:
  s_waitcnt lgkmcnt(0)
  v_readfirstlane_b32 s33, v90
  v_readfirstlane_b32 s50, v91
  ds_read_b32 v90, v14 offset:12
  ds_add_rtn_u32 v91, v14, v15 offset:8
  s_sub_i32 s50, s50, s34
  s_addk_i32 s34, 256
  s_cmp_lt_i32 s50, 64
  s_cselect_b32 s51, 0x700, 0
  s_or_b32 s33, s33, s51
  s_cmp_ge_i32 s50, 192
  s_cselect_b32 s51, 0x7, 0
  s_or_b32 s33, s33, s51
  v_mfma_f32_16x16x32_bf16 v[56:59], v[128:131], v[16:19], 0
  s_bitcmp1_b32 s33, 0
  s_cbranch_scc1 L_t1
  s_bitcmp0_b32 s33, 8
  s_cbranch_scc1 L_u1
  s_waitcnt vmcnt(3)
L_u1:
  s_waitcnt vmcnt(4)
L_t1:
  s_waitcnt vmcnt(6)
  buffer_load_dwordx4 v[128:131], v36, s[36:39], s44 offen offset:0 nt
  v_mfma_f32_16x16x32_bf16 v[56:59], v[132:135], v[20:23], v[56:59]
  s_bitcmp1_b32 s33, 1
  s_cbranch_scc1 L_t2
  s_bitcmp0_b32 s33, 9
  s_cbranch_scc1 L_u2
  s_waitcnt vmcnt(3)
L_u2:
  s_waitcnt vmcnt(4)
L_t2:
  s_waitcnt vmcnt(6)
  buffer_load_dwordx4 v[132:135], v36, s[36:39], s44 offen offset:1024 nt
  v_mfma_f32_16x16x32_bf16 v[56:59], v[136:139], v[24:27], v[56:59]
  s_bitcmp1_b32 s33, 2
  s_cbranch_scc1 L_t3
  s_bitcmp0_b32 s33, 10
  s_cbranch_scc1 L_u3
  s_waitcnt vmcnt(3)
L_u3:
  s_waitcnt vmcnt(4)
L_t3:
  s_waitcnt vmcnt(6)
  buffer_load_dwordx4 v[136:139], v36, s[36:39], s44 offen offset:2048 nt
  v_mfma_f32_16x16x32_bf16 v[56:59], v[140:143], v[28:31], v[56:59]
  s_bitcmp1_b32 s33, 3
  s_cbranch_scc1 L_t4
  s_bitcmp0_b32 s33, 11
  s_cbranch_scc1 L_u4
  s_waitcnt vmcnt(3)
L_u4:
  s_waitcnt vmcnt(4)
L_t4:
  s_waitcnt vmcnt(6)
  buffer_load_dwordx4 v[140:143], v36, s[36:39], s44 offen offset:3072 nt
  s_nop 3
  v_mov_b32_dpp v72, v56 quad_perm:[0,0,0,0] row_mask:0xf bank_mask:0xf
  v_add_f32_dpp v72, v57, v72 quad_perm:[1,1,1,1] row_mask:0xf bank_mask:0xf
  v_add_f32_dpp v72, v58, v72 quad_perm:[2,2,2,2] row_mask:0xf bank_mask:0xf
  v_add_f32_dpp v72, v59, v72 quad_perm:[3,3,3,3] row_mask:0xf bank_mask:0xf
  ds_write_b32 v1, v72 offset:0
  v_max_f32 v8, v8, v72
  v_mfma_f32_16x16x32_bf16 v[56:59], v[144:147], v[16:19], 0
  s_bitcmp1_b32 s33, 4
  s_cbranch_scc1 L_t5
  s_bitcmp0_b32 s33, 12
  s_cbranch_scc1 L_u5
  s_waitcnt vmcnt(3)
L_u5:
  s_waitcnt vmcnt(4)
L_t5:
  s_waitcnt vmcnt(6)
  s_xor_b32 s44, s44, 0x200000
  buffer_load_dwordx4 v[144:147], v36, s[36:39], s44 offen offset:0 nt
  v_mfma_f32_16x16x32_bf16 v[56:59], v[148:151], v[20:23], v[56:59]
  s_bitcmp1_b32 s33, 5
  s_cbranch_scc1 L_t6
  s_bitcmp0_b32 s33, 13
  s_cbranch_scc1 L_u6
  s_waitcnt vmcnt(3)
L_u6:
  s_waitcnt vmcnt(4)
L_t6:
  s_waitcnt vmcnt(6)
  buffer_load_dwordx4 v[148:151], v36, s[36:39], s44 offen offset:1024 nt
  v_mfma_f32_16x16x32_bf16 v[56:59], v[152:155], v[24:27], v[56:59]
  s_bitcmp1_b32 s33, 6
  s_cbranch_scc1 L_t7
  s_bitcmp0_b32 s33, 14
  s_cbranch_scc1 L_u7
  s_waitcnt vmcnt(3)
L_u7:
  s_waitcnt vmcnt(4)
L_t7:
  s_waitcnt vmcnt(6)
  buffer_load_dwordx4 v[152:155], v36, s[36:39], s44 offen offset:2048 nt
  v_mfma_f32_16x16x32_bf16 v[56:59], v[156:159], v[28:31], v[56:59]
  s_bitcmp1_b32 s33, 7
  s_cbranch_scc1 L_t8
  s_bitcmp0_b32 s33, 15
  s_cbranch_scc1 L_u8
  s_waitcnt vmcnt(3)
L_u8:
  s_waitcnt vmcnt(4)
L_t8:
  s_waitcnt vmcnt(6)
  buffer_load_dwordx4 v[156:159], v36, s[36:39], s44 offen offset:3072 nt
  s_sub_u32 s44, s44, s45
  s_and_b32 s44, s44, s45
  s_nop 3
  v_mov_b32_dpp v72, v56 quad_perm:[0,0,0,0] row_mask:0xf bank_mask:0xf
  v_add_f32_dpp v72, v57, v72 quad_perm:[1,1,1,1] row_mask:0xf bank_mask:0xf
  v_add_f32_dpp v72, v58, v72 quad_perm:[2,2,2,2] row_mask:0xf bank_mask:0xf
  v_add_f32_dpp v72, v59, v72 quad_perm:[3,3,3,3] row_mask:0xf bank_mask:0xf
  ds_write_b32 v1, v72 offset:64
  v_max_f32 v8, v8, v72
  s_waitcnt lgkmcnt(0)
  v_readfirstlane_b32 s33, v90
  v_readfirstlane_b32 s50, v91
  ds_read_b32 v90, v14 offset:12
  ds_add_rtn_u32 v91, v14, v15 offset:8
  s_sub_i32 s50, s50, s34
  s_addk_i32 s34, 256
  s_cmp_lt_i32 s50, 64
  s_cselect_b32 s51, 0x700, 0
  s_or_b32 s33, s33, s51
  s_cmp_ge_i32 s50, 192
  s_cselect_b32 s51, 0x7, 0
  s_or_b32 s33, s33, s51
  v_mfma_f32_16x16x32_bf16 v[56:59], v[160:163], v[16:19], 0
  s_bitcmp1_b32 s33, 0
  s_cbranch_scc1 L_t9
  s_bitcmp0_b32 s33, 8
  s_cbranch_scc1 L_u9
  s_waitcnt vmcnt(3)
L_u9:
  s_waitcnt vmcnt(4)
L_t9:
  s_waitcnt vmcnt(6)
  buffer_load_dwordx4 v[160:163], v36, s[36:39], s44 offen offset:0 nt
  v_mfma_f32_16x16x32_bf16 v[56:59], v[164:167], v[20:23], v[56:59]
  s_bitcmp1_b32 s33, 1
  s_cbranch_scc1 L_t10
  s_bitcmp0_b32 s33, 9
  s_cbranch_scc1 L_u10
  s_waitcnt vmcnt(3)
L_u10:
  s_waitcnt vmcnt(4)
L_t10:
  s_waitcnt vmcnt(6)
  buffer_load_dwordx4 v[164:167], v36, s[36:39], s44 offen offset:1024 nt
  v_mfma_f32_16x16x32_bf16 v[56:59], v[168:171], v[24:27], v[56:59]
  s_bitcmp1_b32 s33, 2
  s_cbranch_scc1 L_t11
  s_bitcmp0_b32 s33, 10
  s_cbranch_scc1 L_u11
  s_waitcnt vmcnt(3)
L_u11:
  s_waitcnt vmcnt(4)
L_t11:
  s_waitcnt vmcnt(6)
  buffer_load_dwordx4 v[168:171], v36, s[36:39], s44 offen offset:2048 nt
  v_mfma_f32_16x16x32_bf16 v[56:59], v[172:175], v[28:31], v[56:59]
  s_bitcmp1_b32 s33, 3
  s_cbranch_scc1 L_t12
  s_bitcmp0_b32 s33, 11
  s_cbranch_scc1 L_u12
  s_waitcnt vmcnt(3)
L_u12:
  s_waitcnt vmcnt(4)
L_t12:
  s_waitcnt vmcnt(6)
  buffer_load_dwordx4 v[172:175], v36, s[36:39], s44 offen offset:3072 nt
  s_nop 3
  v_mov_b32_dpp v72, v56 quad_perm:[0,0,0,0] row_mask:0xf bank_mask:0xf
  v_add_f32_dpp v72, v57, v72 quad_perm:[1,1,1,1] row_mask:0xf bank_mask:0xf
  v_add_f32_dpp v72, v58, v72 quad_perm:[2,2,2,2] row_mask:0xf bank_mask:0xf
  v_add_f32_dpp v72, v59, v72 quad_perm:[3,3,3,3] row_mask:0xf bank_mask:0xf
  ds_write_b32 v1, v72 offset:128
  v_max_f32 v8, v8, v72
  v_mfma_f32_16x16x32_bf16 v[56:59], v[176:179], v[16:19], 0
  s_bitcmp1_b32 s33, 4
  s_cbranch_scc1 L_t13
  s_bitcmp0_b32 s33, 12
  s_cbranch_scc1 L_u13
  s_waitcnt vmcnt(3)
L_u13:
  s_waitcnt vmcnt(4)
L_t13:
  s_waitcnt vmcnt(6)
  s_xor_b32 s44, s44, 0x200000
  buffer_load_dwordx4 v[176:179], v36, s[36:39], s44 offen offset:0 nt
  v_mfma_f32_16x16x32_bf16 v[56:59], v[180:183], v[20:23], v[56:59]
  s_bitcmp1_b32 s33, 5
  s_cbranch_scc1 L_t14
  s_bitcmp0_b32 s33, 13
  s_cbranch_scc1 L_u14
  s_waitcnt vmcnt(3)
L_u14:
  s_waitcnt vmcnt(4)
L_t14:
  s_waitcnt vmcnt(6)
  buffer_load_dwordx4 v[180:183], v36, s[36:39], s44 offen offset:1024 nt
  v_mfma_f32_16x16x32_bf16 v[56:59], v[184:187], v[24:27], v[56:59]
  s_bitcmp1_b32 s33, 6
  s_cbranch_scc1 L_t15
  s_bitcmp0_b32 s33, 14
  s_cbranch_scc1 L_u15
  s_waitcnt vmcnt(3)
L_u15:
  s_waitcnt vmcnt(4)
L_t15:
  s_waitcnt vmcnt(6)
  buffer_load_dwordx4 v[184:187], v36, s[36:39], s44 offen offset:2048 nt
  v_mfma_f32_16x16x32_bf16 v[56:59], v[188:191], v[28:31], v[56:59]
  s_bitcmp1_b32 s33, 7
  s_cbranch_scc1 L_t16
  s_bitcmp0_b32 s33, 15
  s_cbranch_scc1 L_u16
  s_waitcnt vmcnt(3)
L_u16:
  s_waitcnt vmcnt(4)
L_t16:
  s_waitcnt vmcnt(6)
  buffer_load_dwordx4 v[188:191], v36, s[36:39], s44 offen offset:3072 nt
  s_sub_u32 s44, s44, s45
  s_and_b32 s44, s44, s45
  s_nop 3
  v_mov_b32_dpp v72, v56 quad_perm:[0,0,0,0] row_mask:0xf bank_mask:0xf
  v_add_f32_dpp v72, v57, v72 quad_perm:[1,1,1,1] row_mask:0xf bank_mask:0xf
  v_add_f32_dpp v72, v58, v72 quad_perm:[2,2,2,2] row_mask:0xf bank_mask:0xf
  v_add_f32_dpp v72, v59, v72 quad_perm:[3,3,3,3] row_mask:0xf bank_mask:0xf
  ds_write_b32 v1, v72 offset:192
  v_max_f32 v8, v8, v72
  s_waitcnt lgkmcnt(0)
  v_readfirstlane_b32 s33, v90
  v_readfirstlane_b32 s50, v91
  ds_read_b32 v90, v14 offset:12
  ds_add_rtn_u32 v91, v14, v15 offset:8
  s_sub_i32 s50, s50, s34
  s_addk_i32 s34, 256
  s_cmp_lt_i32 s50, 64
  s_cselect_b32 s51, 0x700, 0
  s_or_b32 s33, s33, s51
  s_cmp_ge_i32 s50, 192
  s_cselect_b32 s51, 0x7, 0
  s_or_b32 s33, s33, s51
  v_mfma_f32_16x16x32_bf16 v[56:59], v[192:195], v[16:19], 0
  s_bitcmp1_b32 s33, 0
  s_cbranch_scc1 L_t17
  s_bitcmp0_b32 s33, 8
  s_cbranch_scc1 L_u17
  s_waitcnt vmcnt(3)
L_u17:
  s_waitcnt vmcnt(4)
L_t17:
  s_waitcnt vmcnt(6)
  buffer_load_dwordx4 v[192:195], v36, s[36:39], s44 offen offset:0 nt
  v_mfma_f32_16x16x32_bf16 v[56:59], v[196:199], v[20:23], v[56:59]
  s_bitcmp1_b32 s33, 1
  s_cbranch_scc1 L_t18
  s_bitcmp0_b32 s33, 9
  s_cbranch_scc1 L_u18
  s_waitcnt vmcnt(3)
L_u18:
  s_waitcnt vmcnt(4)
L_t18:
  s_waitcnt vmcnt(6)
  buffer_load_dwordx4 v[196:199], v36, s[36:39], s44 offen offset:1024 nt
  v_mfma_f32_16x16x32_bf16 v[56:59], v[200:203], v[24:27], v[56:59]
  s_bitcmp1_b32 s33, 2
  s_cbranch_scc1 L_t19
  s_bitcmp0_b32 s33, 10
  s_cbranch_scc1 L_u19
  s_waitcnt vmcnt(3)
L_u19:
  s_waitcnt vmcnt(4)
L_t19:
  s_waitcnt vmcnt(6)
  buffer_load_dwordx4 v[200:203], v36, s[36:39], s44 offen offset:2048 nt
  v_mfma_f32_16x16x32_bf16 v[56:59], v[204:207], v[28:31], v[56:59]
  s_bitcmp1_b32 s33, 3
  s_cbranch_scc1 L_t20
  s_bitcmp0_b32 s33, 11
  s_cbranch_scc1 L_u20
  s_waitcnt vmcnt(3)
L_u20:
  s_waitcnt vmcnt(4)
L_t20:
  s_waitcnt vmcnt(6)
  buffer_load_dwordx4 v[204:207], v36, s[36:39], s44 offen offset:3072 nt
  s_nop 3
  v_mov_b32_dpp v72, v56 quad_perm:[0,0,0,0] row_mask:0xf bank_mask:0xf
  v_add_f32_dpp v72, v57, v72 quad_perm:[1,1,1,1] row_mask:0xf bank_mask:0xf
  v_add_f32_dpp v72, v58, v72 quad_perm:[2,2,2,2] row_mask:0xf bank_mask:0xf
  v_add_f32_dpp v72, v59, v72 quad_perm:[3,3,3,3] row_mask:0xf bank_mask:0xf
  ds_write_b32 v1, v72 offset:256
  v_max_f32 v8, v8, v72
  v_mfma_f32_16x16x32_bf16 v[56:59], v[208:211], v[16:19], 0
  s_bitcmp1_b32 s33, 4
  s_cbranch_scc1 L_t21
  s_bitcmp0_b32 s33, 12
  s_cbranch_scc1 L_u21
  s_waitcnt vmcnt(3)
L_u21:
  s_waitcnt vmcnt(4)
L_t21:
  s_waitcnt vmcnt(6)
  s_xor_b32 s44, s44, 0x200000
  buffer_load_dwordx4 v[208:211], v36, s[36:39], s44 offen offset:0 nt
  v_mfma_f32_16x16x32_bf16 v[56:59], v[212:215], v[20:23], v[56:59]
  s_bitcmp1_b32 s33, 5
  s_cbranch_scc1 L_t22
  s_bitcmp0_b32 s33, 13
  s_cbranch_scc1 L_u22
  s_waitcnt vmcnt(3)
L_u22:
  s_waitcnt vmcnt(4)
L_t22:
  s_waitcnt vmcnt(6)
  buffer_load_dwordx4 v[212:215], v36, s[36:39], s44 offen offset:1024 nt
  v_mfma_f32_16x16x32_bf16 v[56:59], v[216:219], v[24:27], v[56:59]
  s_bitcmp1_b32 s33, 6
  s_cbranch_scc1 L_t23
  s_bitcmp0_b32 s33, 14
  s_cbranch_scc1 L_u23
  s_waitcnt vmcnt(3)
L_u23:
  s_waitcnt vmcnt(4)
L_t23:
  s_waitcnt vmcnt(6)
  buffer_load_dwordx4 v[216:219], v36, s[36:39], s44 offen offset:2048 nt
  v_mfma_f32_16x16x32_bf16 v[56:59], v[220:223], v[28:31], v[56:59]
  s_bitcmp1_b32 s33, 7
  s_cbranch_scc1 L_t24
  s_bitcmp0_b32 s33, 15
  s_cbranch_scc1 L_u24
  s_waitcnt vmcnt(3)
L_u24:
  s_waitcnt vmcnt(4)
L_t24:
  s_waitcnt vmcnt(6)
  buffer_load_dwordx4 v[220:223], v36, s[36:39], s44 offen offset:3072 nt
  s_sub_u32 s44, s44, s45
  s_and_b32 s44, s44, s45
  s_nop 3
  v_mov_b32_dpp v72, v56 quad_perm:[0,0,0,0] row_mask:0xf bank_mask:0xf
  v_add_f32_dpp v72, v57, v72 quad_perm:[1,1,1,1] row_mask:0xf bank_mask:0xf
  v_add_f32_dpp v72, v58, v72 quad_perm:[2,2,2,2] row_mask:0xf bank_mask:0xf
  v_add_f32_dpp v72, v59, v72 quad_perm:[3,3,3,3] row_mask:0xf bank_mask:0xf
  ds_write_b32 v1, v72 offset:320
  v_max_f32 v8, v8, v72
  s_waitcnt lgkmcnt(0)
  v_readfirstlane_b32 s33, v90
  v_readfirstlane_b32 s50, v91
  ds_read_b32 v90, v14 offset:12
  ds_add_rtn_u32 v91, v14, v15 offset:8
  s_sub_i32 s50, s50, s34
  s_addk_i32 s34, 256
  s_cmp_lt_i32 s50, 64
  s_cselect_b32 s51, 0x700, 0
  s_or_b32 s33, s33, s51
  s_cmp_ge_i32 s50, 192
  s_cselect_b32 s51, 0x7, 0
  s_or_b32 s33, s33, s51
  v_mfma_f32_16x16x32_bf16 v[56:59], v[224:227], v[16:19], 0
  s_bitcmp1_b32 s33, 0
  s_cbranch_scc1 L_t25
  s_bitcmp0_b32 s33, 8
  s_cbranch_scc1 L_u25
  s_waitcnt vmcnt(3)
L_u25:
  s_waitcnt vmcnt(4)
L_t25:
  s_waitcnt vmcnt(6)
  buffer_load_dwordx4 v[224:227], v36, s[36:39], s44 offen offset:0 nt
  v_mfma_f32_16x16x32_bf16 v[56:59], v[228:231], v[20:23], v[56:59]
  s_bitcmp1_b32 s33, 1
  s_cbranch_scc1 L_t26
  s_bitcmp0_b32 s33, 9
  s_cbranch_scc1 L_u26
  s_waitcnt vmcnt(3)
L_u26:
  s_waitcnt vmcnt(4)
L_t26:
  s_waitcnt vmcnt(6)
  buffer_load_dwordx4 v[228:231], v36, s[36:39], s44 offen offset:1024 nt
  v_mfma_f32_16x16x32_bf16 v[56:59], v[232:235], v[24:27], v[56:59]
  s_bitcmp1_b32 s33, 2
  s_cbranch_scc1 L_t27
  s_bitcmp0_b32 s33, 10
  s_cbranch_scc1 L_u27
  s_waitcnt vmcnt(3)
L_u27:
  s_waitcnt vmcnt(4)
L_t27:
  s_waitcnt vmcnt(6)
  buffer_load_dwordx4 v[232:235], v36, s[36:39], s44 offen offset:2048 nt
  v_mfma_f32_16x16x32_bf16 v[56:59], v[236:239], v[28:31], v[56:59]
  s_bitcmp1_b32 s33, 3
  s_cbranch_scc1 L_t28
  s_bitcmp0_b32 s33, 11
  s_cbranch_scc1 L_u28
  s_waitcnt vmcnt(3)
L_u28:
  s_waitcnt vmcnt(4)
L_t28:
  s_waitcnt vmcnt(6)
  buffer_load_dwordx4 v[236:239], v36, s[36:39], s44 offen offset:3072 nt
  s_nop 3
  v_mov_b32_dpp v72, v56 quad_perm:[0,0,0,0] row_mask:0xf bank_mask:0xf
  v_add_f32_dpp v72, v57, v72 quad_perm:[1,1,1,1] row_mask:0xf bank_mask:0xf
  v_add_f32_dpp v72, v58, v72 quad_perm:[2,2,2,2] row_mask:0xf bank_mask:0xf
  v_add_f32_dpp v72, v59, v72 quad_perm:[3,3,3,3] row_mask:0xf bank_mask:0xf
  ds_write_b32 v1, v72 offset:384
  v_max_f32 v8, v8, v72
  v_mfma_f32_16x16x32_bf16 v[56:59], v[240:243], v[16:19], 0
  s_bitcmp1_b32 s33, 4
  s_cbranch_scc1 L_t29
  s_bitcmp0_b32 s33, 12
  s_cbranch_scc1 L_u29
  s_waitcnt vmcnt(3)
L_u29:
  s_waitcnt vmcnt(4)
L_t29:
  s_waitcnt vmcnt(6)
  s_xor_b32 s44, s44, 0x200000
  buffer_load_dwordx4 v[240:243], v36, s[36:39], s44 offen offset:0 nt
  v_mfma_f32_16x16x32_bf16 v[56:59], v[244:247], v[20:23], v[56:59]
  s_bitcmp1_b32 s33, 5
  s_cbranch_scc1 L_t30
  s_bitcmp0_b32 s33, 13
  s_cbranch_scc1 L_u30
  s_waitcnt vmcnt(3)
L_u30:
  s_waitcnt vmcnt(4)
L_t30:
  s_waitcnt vmcnt(6)
  buffer_load_dwordx4 v[244:247], v36, s[36:39], s44 offen offset:1024 nt
  v_mfma_f32_16x16x32_bf16 v[56:59], v[248:251], v[24:27], v[56:59]
  s_bitcmp1_b32 s33, 6
  s_cbranch_scc1 L_t31
  s_bitcmp0_b32 s33, 14
  s_cbranch_scc1 L_u31
  s_waitcnt vmcnt(3)
L_u31:
  s_waitcnt vmcnt(4)
L_t31:
  s_waitcnt vmcnt(6)
  buffer_load_dwordx4 v[248:251], v36, s[36:39], s44 offen offset:2048 nt
  v_mfma_f32_16x16x32_bf16 v[56:59], v[252:255], v[28:31], v[56:59]
  s_bitcmp1_b32 s33, 7
  s_cbranch_scc1 L_t32
  s_bitcmp0_b32 s33, 15
  s_cbranch_scc1 L_u32
  s_waitcnt vmcnt(3)
L_u32:
  s_waitcnt vmcnt(4)
L_t32:
  s_waitcnt vmcnt(6)
  buffer_load_dwordx4 v[252:255], v36, s[36:39], s44 offen offset:3072 nt
  s_sub_u32 s44, s44, s45
  s_and_b32 s44, s44, s45
  s_nop 3
  v_mov_b32_dpp v72, v56 quad_perm:[0,0,0,0] row_mask:0xf bank_mask:0xf
  v_add_f32_dpp v72, v57, v72 quad_perm:[1,1,1,1] row_mask:0xf bank_mask:0xf
  v_add_f32_dpp v72, v58, v72 quad_perm:[2,2,2,2] row_mask:0xf bank_mask:0xf
  v_add_f32_dpp v72, v59, v72 quad_perm:[3,3,3,3] row_mask:0xf bank_mask:0xf
  ds_write_b32 v1, v72 offset:448
  v_max_f32 v8, v8, v72
  v_add_u32 v1, 512, v1
  s_sub_u32 s47, s47, 1
  s_cmp_lg_u32 s47, 0
  s_cbranch_scc1 L_km
  s_mov_b32 s50, 33554432
L_wqb:
  ds_read_b32 v7, v14
  ds_read_b128 v[32:35], v2 offset:1024
  s_waitcnt lgkmcnt(0)
  v_readfirstlane_b32 s51, v7
  s_sub_u32 s50, s50, 1
  s_cbranch_scc1 L_wqb_done
  s_cmp_eq_u32 s51, 0
  s_cbranch_scc1 L_wqb
L_wqb_done:
  s_mov_b32 s47, 2
  v_mov_b32 v1, v39
L_kg:
  s_cmp_lg_u32 s47, 1
  s_cbranch_scc1 L_kg_go
  s_add_u32 s36, s18, s41
  s_addc_u32 s37, s19, 0
  v_mov_b32 v36, v3
L_kg_go:
  s_waitcnt lgkmcnt(0)
  v_readfirstlane_b32 s33, v90
  v_readfirstlane_b32 s50, v91
  ds_read_b32 v90, v14 offset:12
  ds_add_rtn_u32 v91, v14, v15 offset:8
  s_sub_i32 s50, s50, s34
  s_addk_i32 s34, 256
  s_cmp_lt_i32 s50, 64
  s_cselect_b32 s51, 0x700, 0
  s_or_b32 s33, s33, s51
  s_cmp_ge_i32 s50, 192
  s_cselect_b32 s51, 0x7, 0
  s_or_b32 s33, s33, s51
  v_mfma_f32_16x16x32_bf16 v[56:59], v[128:131], v[32:35], 0
  s_bitcmp1_b32 s33, 0
  s_cbranch_scc1 L_t33
  s_bitcmp0_b32 s33, 8
  s_cbranch_scc1 L_u33
  s_waitcnt vmcnt(3)
L_u33:
  s_waitcnt vmcnt(4)
L_t33:
  s_waitcnt vmcnt(6)
  buffer_load_dwordx4 v[128:131], v36, s[36:39], s44 offen offset:0 nt
  v_mfma_f32_16x16x32_bf16 v[60:63], v[132:135], v[32:35], 0
  s_bitcmp1_b32 s33, 1
  s_cbranch_scc1 L_t34
  s_bitcmp0_b32 s33, 9
  s_cbranch_scc1 L_u34
  s_waitcnt vmcnt(3)
L_u34:
  s_waitcnt vmcnt(4)
L_t34:
  s_waitcnt vmcnt(6)
  buffer_load_dwordx4 v[132:135], v36, s[36:39], s44 offen offset:1024 nt
  v_mfma_f32_16x16x32_bf16 v[64:67], v[136:139], v[32:35], 0
  s_bitcmp1_b32 s33, 2
  s_cbranch_scc1 L_t35
  s_bitcmp0_b32 s33, 10
  s_cbranch_scc1 L_u35
  s_waitcnt vmcnt(3)
L_u35:
  s_waitcnt vmcnt(4)
L_t35:
  s_waitcnt vmcnt(6)
  buffer_load_dwordx4 v[136:139], v36, s[36:39], s44 offen offset:2048 nt
  v_mfma_f32_16x16x32_bf16 v[68:71], v[140:143], v[32:35], 0
  s_bitcmp1_b32 s33, 3
  s_cbranch_scc1 L_t36
  s_bitcmp0_b32 s33, 11
  s_cbranch_scc1 L_u36
  s_waitcnt vmcnt(3)
L_u36:
  s_waitcnt vmcnt(4)
L_t36:
  s_waitcnt vmcnt(6)
  buffer_load_dwordx4 v[140:143], v36, s[36:39], s44 offen offset:3072 nt
  v_mov_b32_dpp v72, v56 quad_perm:[0,0,0,0] row_mask:0xf bank_mask:0xf
  v_add_f32_dpp v72, v57, v72 quad_perm:[1,1,1,1] row_mask:0xf bank_mask:0xf
  v_add_f32_dpp v72, v58, v72 quad_perm:[2,2,2,2] row_mask:0xf bank_mask:0xf
  v_add_f32_dpp v72, v59, v72 quad_perm:[3,3,3,3] row_mask:0xf bank_mask:0xf
  v_mov_b32_dpp v73, v60 quad_perm:[0,0,0,0] row_mask:0xf bank_mask:0xf
  v_add_f32_dpp v73, v61, v73 quad_perm:[1,1,1,1] row_mask:0xf bank_mask:0xf
  v_add_f32_dpp v73, v62, v73 quad_perm:[2,2,2,2] row_mask:0xf bank_mask:0xf
  v_add_f32_dpp v73, v63, v73 quad_perm:[3,3,3,3] row_mask:0xf bank_mask:0xf
  v_mov_b32_dpp v74, v64 quad_perm:[0,0,0,0] row_mask:0xf bank_mask:0xf
  v_add_f32_dpp v74, v65, v74 quad_perm:[1,1,1,1] row_mask:0xf bank_mask:0xf
  v_add_f32_dpp v74, v66, v74 quad_perm:[2,2,2,2] row_mask:0xf bank_mask:0xf
  v_add_f32_dpp v74, v67, v74 quad_perm:[3,3,3,3] row_mask:0xf bank_mask:0xf
  v_mov_b32_dpp v75, v68 quad_perm:[0,0,0,0] row_mask:0xf bank_mask:0xf
  v_add_f32_dpp v75, v69, v75 quad_perm:[1,1,1,1] row_mask:0xf bank_mask:0xf
  v_add_f32_dpp v75, v70, v75 quad_perm:[2,2,2,2] row_mask:0xf bank_mask:0xf
  v_add_f32_dpp v75, v71, v75 quad_perm:[3,3,3,3] row_mask:0xf bank_mask:0xf
  ds_write_b128 v1, v[72:75] offset:0
  v_max3_f32 v11, v11, v72, v73
  v_max3_f32 v11, v11, v74, v75
  v_mfma_f32_16x16x32_bf16 v[56:59], v[144:147], v[32:35], 0
  s_bitcmp1_b32 s33, 4
  s_cbranch_scc1 L_t37
  s_bitcmp0_b32 s33, 12
  s_cbranch_scc1 L_u37
  s_waitcnt vmcnt(3)
L_u37:
  s_waitcnt vmcnt(4)
L_t37:
  s_waitcnt vmcnt(6)
  s_xor_b32 s44, s44, 0x200000
  buffer_load_dwordx4 v[144:147], v36, s[36:39], s44 offen offset:0 nt
  v_mfma_f32_16x16x32_bf16 v[60:63], v[148:151], v[32:35], 0
  s_bitcmp1_b32 s33, 5
  s_cbranch_scc1 L_t38
  s_bitcmp0_b32 s33, 13
  s_cbranch_scc1 L_u38
  s_waitcnt vmcnt(3)
L_u38:
  s_waitcnt vmcnt(4)
L_t38:
  s_waitcnt vmcnt(6)
  buffer_load_dwordx4 v[148:151], v36, s[36:39], s44 offen offset:1024 nt
  v_mfma_f32_16x16x32_bf16 v[64:67], v[152:155], v[32:35], 0
  s_bitcmp1_b32 s33, 6
  s_cbranch_scc1 L_t39
  s_bitcmp0_b32 s33, 14
  s_cbranch_scc1 L_u39
  s_waitcnt vmcnt(3)
L_u39:
  s_waitcnt vmcnt(4)
L_t39:
  s_waitcnt vmcnt(6)
  buffer_load_dwordx4 v[152:155], v36, s[36:39], s44 offen offset:2048 nt
  v_mfma_f32_16x16x32_bf16 v[68:71], v[156:159], v[32:35], 0
  s_bitcmp1_b32 s33, 7
  s_cbranch_scc1 L_t40
  s_bitcmp0_b32 s33, 15
  s_cbranch_scc1 L_u40
  s_waitcnt vmcnt(3)
L_u40:
  s_waitcnt vmcnt(4)
L_t40:
  s_waitcnt vmcnt(6)
  buffer_load_dwordx4 v[156:159], v36, s[36:39], s44 offen offset:3072 nt
  s_sub_u32 s44, s44, s45
  s_and_b32 s44, s44, s45
  v_mov_b32_dpp v72, v56 quad_perm:[0,0,0,0] row_mask:0xf bank_mask:0xf
  v_add_f32_dpp v72, v57, v72 quad_perm:[1,1,1,1] row_mask:0xf bank_mask:0xf
  v_add_f32_dpp v72, v58, v72 quad_perm:[2,2,2,2] row_mask:0xf bank_mask:0xf
  v_add_f32_dpp v72, v59, v72 quad_perm:[3,3,3,3] row_mask:0xf bank_mask:0xf
  v_mov_b32_dpp v73, v60 quad_perm:[0,0,0,0] row_mask:0xf bank_mask:0xf
  v_add_f32_dpp v73, v61, v73 quad_perm:[1,1,1,1] row_mask:0xf bank_mask:0xf
  v_add_f32_dpp v73, v62, v73 quad_perm:[2,2,2,2] row_mask:0xf bank_mask:0xf
  v_add_f32_dpp v73, v63, v73 quad_perm:[3,3,3,3] row_mask:0xf bank_mask:0xf
  v_mov_b32_dpp v74, v64 quad_perm:[0,0,0,0] row_mask:0xf bank_mask:0xf
  v_add_f32_dpp v74, v65, v74 quad_perm:[1,1,1,1] row_mask:0xf bank_mask:0xf
  v_add_f32_dpp v74, v66, v74 quad_perm:[2,2,2,2] row_mask:0xf bank_mask:0xf
  v_add_f32_dpp v74, v67, v74 quad_perm:[3,3,3,3] row_mask:0xf bank_mask:0xf
  v_mov_b32_dpp v75, v68 quad_perm:[0,0,0,0] row_mask:0xf bank_mask:0xf
  v_add_f32_dpp v75, v69, v75 quad_perm:[1,1,1,1] row_mask:0xf bank_mask:0xf
  v_add_f32_dpp v75, v70, v75 quad_perm:[2,2,2,2] row_mask:0xf bank_mask:0xf
  v_add_f32_dpp v75, v71, v75 quad_perm:[3,3,3,3] row_mask:0xf bank_mask:0xf
  ds_write_b128 v1, v[72:75] offset:256
  v_max3_f32 v11, v11, v72, v73
  v_max3_f32 v11, v11, v74, v75
  s_waitcnt lgkmcnt(0)
  v_readfirstlane_b32 s33, v90
  v_readfirstlane_b32 s50, v91
  ds_read_b32 v90, v14 offset:12
  ds_add_rtn_u32 v91, v14, v15 offset:8
  s_sub_i32 s50, s50, s34
  s_addk_i32 s34, 256
  s_cmp_lt_i32 s50, 64
  s_cselect_b32 s51, 0x700, 0
  s_or_b32 s33, s33, s51
  s_cmp_ge_i32 s50, 192
  s_cselect_b32 s51, 0x7, 0
  s_or_b32 s33, s33, s51
  v_mfma_f32_16x16x32_bf16 v[56:59], v[160:163], v[32:35], 0
  s_bitcmp1_b32 s33, 0
  s_cbranch_scc1 L_t41
  s_bitcmp0_b32 s33, 8
  s_cbranch_scc1 L_u41
  s_waitcnt vmcnt(3)
L_u41:
  s_waitcnt vmcnt(4)
L_t41:
  s_waitcnt vmcnt(6)
  buffer_load_dwordx4 v[160:163], v36, s[36:39], s44 offen offset:0 nt
  v_mfma_f32_16x16x32_bf16 v[60:63], v[164:167], v[32:35], 0
  s_bitcmp1_b32 s33, 1
  s_cbranch_scc1 L_t42
  s_bitcmp0_b32 s33, 9
  s_cbranch_scc1 L_u42
  s_waitcnt vmcnt(3)
L_u42:
  s_waitcnt vmcnt(4)
L_t42:
  s_waitcnt vmcnt(6)
  buffer_load_dwordx4 v[164:167], v36, s[36:39], s44 offen offset:1024 nt
  v_mfma_f32_16x16x32_bf16 v[64:67], v[168:171], v[32:35], 0
  s_bitcmp1_b32 s33, 2
  s_cbranch_scc1 L_t43
  s_bitcmp0_b32 s33, 10
  s_cbranch_scc1 L_u43
  s_waitcnt vmcnt(3)
L_u43:
  s_waitcnt vmcnt(4)
L_t43:
  s_waitcnt vmcnt(6)
  buffer_load_dwordx4 v[168:171], v36, s[36:39], s44 offen offset:2048 nt
  v_mfma_f32_16x16x32_bf16 v[68:71], v[172:175], v[32:35], 0
  s_bitcmp1_b32 s33, 3
  s_cbranch_scc1 L_t44
  s_bitcmp0_b32 s33, 11
  s_cbranch_scc1 L_u44
  s_waitcnt vmcnt(3)
L_u44:
  s_waitcnt vmcnt(4)
L_t44:
  s_waitcnt vmcnt(6)
  buffer_load_dwordx4 v[172:175], v36, s[36:39], s44 offen offset:3072 nt
  v_mov_b32_dpp v72, v56 quad_perm:[0,0,0,0] row_mask:0xf bank_mask:0xf
  v_add_f32_dpp v72, v57, v72 quad_perm:[1,1,1,1] row_mask:0xf bank_mask:0xf
  v_add_f32_dpp v72, v58, v72 quad_perm:[2,2,2,2] row_mask:0xf bank_mask:0xf
  v_add_f32_dpp v72, v59, v72 quad_perm:[3,3,3,3] row_mask:0xf bank_mask:0xf
  v_mov_b32_dpp v73, v60 quad_perm:[0,0,0,0] row_mask:0xf bank_mask:0xf
  v_add_f32_dpp v73, v61, v73 quad_perm:[1,1,1,1] row_mask:0xf bank_mask:0xf
  v_add_f32_dpp v73, v62, v73 quad_perm:[2,2,2,2] row_mask:0xf bank_mask:0xf
  v_add_f32_dpp v73, v63, v73 quad_perm:[3,3,3,3] row_mask:0xf bank_mask:0xf
  v_mov_b32_dpp v74, v64 quad_perm:[0,0,0,0] row_mask:0xf bank_mask:0xf
  v_add_f32_dpp v74, v65, v74 quad_perm:[1,1,1,1] row_mask:0xf bank_mask:0xf
  v_add_f32_dpp v74, v66, v74 quad_perm:[2,2,2,2] row_mask:0xf bank_mask:0xf
  v_add_f32_dpp v74, v67, v74 quad_perm:[3,3,3,3] row_mask:0xf bank_mask:0xf
  v_mov_b32_dpp v75, v68 quad_perm:[0,0,0,0] row_mask:0xf bank_mask:0xf
  v_add_f32_dpp v75, v69, v75 quad_perm:[1,1,1,1] row_mask:0xf bank_mask:0xf
  v_add_f32_dpp v75, v70, v75 quad_perm:[2,2,2,2] row_mask:0xf bank_mask:0xf
  v_add_f32_dpp v75, v71, v75 quad_perm:[3,3,3,3] row_mask:0xf bank_mask:0xf
  ds_write_b128 v1, v[72:75] offset:512
  v_max3_f32 v11, v11, v72, v73
  v_max3_f32 v11, v11, v74, v75
  v_mfma_f32_16x16x32_bf16 v[56:59], v[176:179], v[32:35], 0
  s_bitcmp1_b32 s33, 4
  s_cbranch_scc1 L_t45
  s_bitcmp0_b32 s33, 12
  s_cbranch_scc1 L_u45
  s_waitcnt vmcnt(3)
L_u45:
  s_waitcnt vmcnt(4)
L_t45:
  s_waitcnt vmcnt(6)
  s_xor_b32 s44, s44, 0x200000
  buffer_load_dwordx4 v[176:179], v36, s[36:39], s44 offen offset:0 nt
  v_mfma_f32_16x16x32_bf16 v[60:63], v[180:183], v[32:35], 0
  s_bitcmp1_b32 s33, 5
  s_cbranch_scc1 L_t46
  s_bitcmp0_b32 s33, 13
  s_cbranch_scc1 L_u46
  s_waitcnt vmcnt(3)
L_u46:
  s_waitcnt vmcnt(4)
L_t46:
  s_waitcnt vmcnt(6)
  buffer_load_dwordx4 v[180:183], v36, s[36:39], s44 offen offset:1024 nt
  v_mfma_f32_16x16x32_bf16 v[64:67], v[184:187], v[32:35], 0
  s_bitcmp1_b32 s33, 6
  s_cbranch_scc1 L_t47
  s_bitcmp0_b32 s33, 14
  s_cbranch_scc1 L_u47
  s_waitcnt vmcnt(3)
L_u47:
  s_waitcnt vmcnt(4)
L_t47:
  s_waitcnt vmcnt(6)
  buffer_load_dwordx4 v[184:187], v36, s[36:39], s44 offen offset:2048 nt
  v_mfma_f32_16x16x32_bf16 v[68:71], v[188:191], v[32:35], 0
  s_bitcmp1_b32 s33, 7
  s_cbranch_scc1 L_t48
  s_bitcmp0_b32 s33, 15
  s_cbranch_scc1 L_u48
  s_waitcnt vmcnt(3)
L_u48:
  s_waitcnt vmcnt(4)
L_t48:
  s_waitcnt vmcnt(6)
  buffer_load_dwordx4 v[188:191], v36, s[36:39], s44 offen offset:3072 nt
  s_sub_u32 s44, s44, s45
  s_and_b32 s44, s44, s45
  v_mov_b32_dpp v72, v56 quad_perm:[0,0,0,0] row_mask:0xf bank_mask:0xf
  v_add_f32_dpp v72, v57, v72 quad_perm:[1,1,1,1] row_mask:0xf bank_mask:0xf
  v_add_f32_dpp v72, v58, v72 quad_perm:[2,2,2,2] row_mask:0xf bank_mask:0xf
  v_add_f32_dpp v72, v59, v72 quad_perm:[3,3,3,3] row_mask:0xf bank_mask:0xf
  v_mov_b32_dpp v73, v60 quad_perm:[0,0,0,0] row_mask:0xf bank_mask:0xf
  v_add_f32_dpp v73, v61, v73 quad_perm:[1,1,1,1] row_mask:0xf bank_mask:0xf
  v_add_f32_dpp v73, v62, v73 quad_perm:[2,2,2,2] row_mask:0xf bank_mask:0xf
  v_add_f32_dpp v73, v63, v73 quad_perm:[3,3,3,3] row_mask:0xf bank_mask:0xf
  v_mov_b32_dpp v74, v64 quad_perm:[0,0,0,0] row_mask:0xf bank_mask:0xf
  v_add_f32_dpp v74, v65, v74 quad_perm:[1,1,1,1] row_mask:0xf bank_mask:0xf
  v_add_f32_dpp v74, v66, v74 quad_perm:[2,2,2,2] row_mask:0xf bank_mask:0xf
  v_add_f32_dpp v74, v67, v74 quad_perm:[3,3,3,3] row_mask:0xf bank_mask:0xf
  v_mov_b32_dpp v75, v68 quad_perm:[0,0,0,0] row_mask:0xf bank_mask:0xf
  v_add_f32_dpp v75, v69, v75 quad_perm:[1,1,1,1] row_mask:0xf bank_mask:0xf
  v_add_f32_dpp v75, v70, v75 quad_perm:[2,2,2,2] row_mask:0xf bank_mask:0xf
  v_add_f32_dpp v75, v71, v75 quad_perm:[3,3,3,3] row_mask:0xf bank_mask:0xf
  ds_write_b128 v1, v[72:75] offset:768
  v_max3_f32 v11, v11, v72, v73
  v_max3_f32 v11, v11, v74, v75
  s_waitcnt lgkmcnt(0)
  v_readfirstlane_b32 s33, v90
  v_readfirstlane_b32 s50, v91
  ds_read_b32 v90, v14 offset:12
  ds_add_rtn_u32 v91, v14, v15 offset:8
  s_sub_i32 s50, s50, s34
  s_addk_i32 s34, 256
  s_cmp_lt_i32 s50, 64
  s_cselect_b32 s51, 0x700, 0
  s_or_b32 s33, s33, s51
  s_cmp_ge_i32 s50, 192
  s_cselect_b32 s51, 0x7, 0
  s_or_b32 s33, s33, s51
  v_mfma_f32_16x16x32_bf16 v[56:59], v[192:195], v[32:35], 0
  s_bitcmp1_b32 s33, 0
  s_cbranch_scc1 L_t49
  s_bitcmp0_b32 s33, 8
  s_cbranch_scc1 L_u49
  s_waitcnt vmcnt(3)
L_u49:
  s_waitcnt vmcnt(4)
L_t49:
  s_waitcnt vmcnt(6)
  buffer_load_dwordx4 v[192:195], v36, s[36:39], s44 offen offset:0 nt
  v_mfma_f32_16x16x32_bf16 v[60:63], v[196:199], v[32:35], 0
  s_bitcmp1_b32 s33, 1
  s_cbranch_scc1 L_t50
  s_bitcmp0_b32 s33, 9
  s_cbranch_scc1 L_u50
  s_waitcnt vmcnt(3)
L_u50:
  s_waitcnt vmcnt(4)
L_t50:
  s_waitcnt vmcnt(6)
  buffer_load_dwordx4 v[196:199], v36, s[36:39], s44 offen offset:1024 nt
  v_mfma_f32_16x16x32_bf16 v[64:67], v[200:203], v[32:35], 0
  s_bitcmp1_b32 s33, 2
  s_cbranch_scc1 L_t51
  s_bitcmp0_b32 s33, 10
  s_cbranch_scc1 L_u51
  s_waitcnt vmcnt(3)
L_u51:
  s_waitcnt vmcnt(4)
L_t51:
  s_waitcnt vmcnt(6)
  buffer_load_dwordx4 v[200:203], v36, s[36:39], s44 offen offset:2048 nt
  v_mfma_f32_16x16x32_bf16 v[68:71], v[204:207], v[32:35], 0
  s_bitcmp1_b32 s33, 3
  s_cbranch_scc1 L_t52
  s_bitcmp0_b32 s33, 11
  s_cbranch_scc1 L_u52
  s_waitcnt vmcnt(3)
L_u52:
  s_waitcnt vmcnt(4)
L_t52:
  s_waitcnt vmcnt(6)
  buffer_load_dwordx4 v[204:207], v36, s[36:39], s44 offen offset:3072 nt
  v_mov_b32_dpp v72, v56 quad_perm:[0,0,0,0] row_mask:0xf bank_mask:0xf
  v_add_f32_dpp v72, v57, v72 quad_perm:[1,1,1,1] row_mask:0xf bank_mask:0xf
  v_add_f32_dpp v72, v58, v72 quad_perm:[2,2,2,2] row_mask:0xf bank_mask:0xf
  v_add_f32_dpp v72, v59, v72 quad_perm:[3,3,3,3] row_mask:0xf bank_mask:0xf
  v_mov_b32_dpp v73, v60 quad_perm:[0,0,0,0] row_mask:0xf bank_mask:0xf
  v_add_f32_dpp v73, v61, v73 quad_perm:[1,1,1,1] row_mask:0xf bank_mask:0xf
  v_add_f32_dpp v73, v62, v73 quad_perm:[2,2,2,2] row_mask:0xf bank_mask:0xf
  v_add_f32_dpp v73, v63, v73 quad_perm:[3,3,3,3] row_mask:0xf bank_mask:0xf
  v_mov_b32_dpp v74, v64 quad_perm:[0,0,0,0] row_mask:0xf bank_mask:0xf
  v_add_f32_dpp v74, v65, v74 quad_perm:[1,1,1,1] row_mask:0xf bank_mask:0xf
  v_add_f32_dpp v74, v66, v74 quad_perm:[2,2,2,2] row_mask:0xf bank_mask:0xf
  v_add_f32_dpp v74, v67, v74 quad_perm:[3,3,3,3] row_mask:0xf bank_mask:0xf
  v_mov_b32_dpp v75, v68 quad_perm:[0,0,0,0] row_mask:0xf bank_mask:0xf
  v_add_f32_dpp v75, v69, v75 quad_perm:[1,1,1,1] row_mask:0xf bank_mask:0xf
  v_add_f32_dpp v75, v70, v75 quad_perm:[2,2,2,2] row_mask:0xf bank_mask:0xf
  v_add_f32_dpp v75, v71, v75 quad_perm:[3,3,3,3] row_mask:0xf bank_mask:0xf
  ds_write_b128 v1, v[72:75] offset:1024
  v_max3_f32 v11, v11, v72, v73
  v_max3_f32 v11, v11, v74, v75
  v_mfma_f32_16x16x32_bf16 v[56:59], v[208:211], v[32:35], 0
  s_bitcmp1_b32 s33, 4
  s_cbranch_scc1 L_t53
  s_bitcmp0_b32 s33, 12
  s_cbranch_scc1 L_u53
  s_waitcnt vmcnt(3)
L_u53:
  s_waitcnt vmcnt(4)
L_t53:
  s_waitcnt vmcnt(6)
  s_xor_b32 s44, s44, 0x200000
  buffer_load_dwordx4 v[208:211], v36, s[36:39], s44 offen offset:0 nt
  v_mfma_f32_16x16x32_bf16 v[60:63], v[212:215], v[32:35], 0
  s_bitcmp1_b32 s33, 5
  s_cbranch_scc1 L_t54
  s_bitcmp0_b32 s33, 13
  s_cbranch_scc1 L_u54
  s_waitcnt vmcnt(3)
L_u54:
  s_waitcnt vmcnt(4)
L_t54:
  s_waitcnt vmcnt(6)
  buffer_load_dwordx4 v[212:215], v36, s[36:39], s44 offen offset:1024 nt
  v_mfma_f32_16x16x32_bf16 v[64:67], v[216:219], v[32:35], 0
  s_bitcmp1_b32 s33, 6
  s_cbranch_scc1 L_t55
  s_bitcmp0_b32 s33, 14
  s_cbranch_scc1 L_u55
  s_waitcnt vmcnt(3)
L_u55:
  s_waitcnt vmcnt(4)
L_t55:
  s_waitcnt vmcnt(6)
  buffer_load_dwordx4 v[216:219], v36, s[36:39], s44 offen offset:2048 nt
  v_mfma_f32_16x16x32_bf16 v[68:71], v[220:223], v[32:35], 0
  s_bitcmp1_b32 s33, 7
  s_cbranch_scc1 L_t56
  s_bitcmp0_b32 s33, 15
  s_cbranch_scc1 L_u56
  s_waitcnt vmcnt(3)
L_u56:
  s_waitcnt vmcnt(4)
L_t56:
  s_waitcnt vmcnt(6)
  buffer_load_dwordx4 v[220:223], v36, s[36:39], s44 offen offset:3072 nt
  s_sub_u32 s44, s44, s45
  s_and_b32 s44, s44, s45
  v_mov_b32_dpp v72, v56 quad_perm:[0,0,0,0] row_mask:0xf bank_mask:0xf
  v_add_f32_dpp v72, v57, v72 quad_perm:[1,1,1,1] row_mask:0xf bank_mask:0xf
  v_add_f32_dpp v72, v58, v72 quad_perm:[2,2,2,2] row_mask:0xf bank_mask:0xf
  v_add_f32_dpp v72, v59, v72 quad_perm:[3,3,3,3] row_mask:0xf bank_mask:0xf
  v_mov_b32_dpp v73, v60 quad_perm:[0,0,0,0] row_mask:0xf bank_mask:0xf
  v_add_f32_dpp v73, v61, v73 quad_perm:[1,1,1,1] row_mask:0xf bank_mask:0xf
  v_add_f32_dpp v73, v62, v73 quad_perm:[2,2,2,2] row_mask:0xf bank_mask:0xf
  v_add_f32_dpp v73, v63, v73 quad_perm:[3,3,3,3] row_mask:0xf bank_mask:0xf
  v_mov_b32_dpp v74, v64 quad_perm:[0,0,0,0] row_mask:0xf bank_mask:0xf
  v_add_f32_dpp v74, v65, v74 quad_perm:[1,1,1,1] row_mask:0xf bank_mask:0xf
  v_add_f32_dpp v74, v66, v74 quad_perm:[2,2,2,2] row_mask:0xf bank_mask:0xf
  v_add_f32_dpp v74, v67, v74 quad_perm:[3,3,3,3] row_mask:0xf bank_mask:0xf
  v_mov_b32_dpp v75, v68 quad_perm:[0,0,0,0] row_mask:0xf bank_mask:0xf
  v_add_f32_dpp v75, v69, v75 quad_perm:[1,1,1,1] row_mask:0xf bank_mask:0xf
  v_add_f32_dpp v75, v70, v75 quad_perm:[2,2,2,2] row_mask:0xf bank_mask:0xf
  v_add_f32_dpp v75, v71, v75 quad_perm:[3,3,3,3] row_mask:0xf bank_mask:0xf
  ds_write_b128 v1, v[72:75] offset:1280
  v_max3_f32 v11, v11, v72, v73
  v_max3_f32 v11, v11, v74, v75
  s_waitcnt lgkmcnt(0)
  v_readfirstlane_b32 s33, v90
  v_readfirstlane_b32 s50, v91
  ds_read_b32 v90, v14 offset:12
  ds_add_rtn_u32 v91, v14, v15 offset:8
  s_sub_i32 s50, s50, s34
  s_addk_i32 s34, 256
  s_cmp_lt_i32 s50, 64
  s_cselect_b32 s51, 0x700, 0
  s_or_b32 s33, s33, s51
  s_cmp_ge_i32 s50, 192
  s_cselect_b32 s51, 0x7, 0
  s_or_b32 s33, s33, s51
  v_mfma_f32_16x16x32_bf16 v[56:59], v[224:227], v[32:35], 0
  s_bitcmp1_b32 s33, 0
  s_cbranch_scc1 L_t57
  s_bitcmp0_b32 s33, 8
  s_cbranch_scc1 L_u57
  s_waitcnt vmcnt(3)
L_u57:
  s_waitcnt vmcnt(4)
L_t57:
  s_waitcnt vmcnt(6)
  buffer_load_dwordx4 v[224:227], v36, s[36:39], s44 offen offset:0 nt
  v_mfma_f32_16x16x32_bf16 v[60:63], v[228:231], v[32:35], 0
  s_bitcmp1_b32 s33, 1
  s_cbranch_scc1 L_t58
  s_bitcmp0_b32 s33, 9
  s_cbranch_scc1 L_u58
  s_waitcnt vmcnt(3)
L_u58:
  s_waitcnt vmcnt(4)
L_t58:
  s_waitcnt vmcnt(6)
  buffer_load_dwordx4 v[228:231], v36, s[36:39], s44 offen offset:1024 nt
  v_mfma_f32_16x16x32_bf16 v[64:67], v[232:235], v[32:35], 0
  s_bitcmp1_b32 s33, 2
  s_cbranch_scc1 L_t59
  s_bitcmp0_b32 s33, 10
  s_cbranch_scc1 L_u59
  s_waitcnt vmcnt(3)
L_u59:
  s_waitcnt vmcnt(4)
L_t59:
  s_waitcnt vmcnt(6)
  buffer_load_dwordx4 v[232:235], v36, s[36:39], s44 offen offset:2048 nt
  v_mfma_f32_16x16x32_bf16 v[68:71], v[236:239], v[32:35], 0
  s_bitcmp1_b32 s33, 3
  s_cbranch_scc1 L_t60
  s_bitcmp0_b32 s33, 11
  s_cbranch_scc1 L_u60
  s_waitcnt vmcnt(3)
L_u60:
  s_waitcnt vmcnt(4)
L_t60:
  s_waitcnt vmcnt(6)
  buffer_load_dwordx4 v[236:239], v36, s[36:39], s44 offen offset:3072 nt
  v_mov_b32_dpp v72, v56 quad_perm:[0,0,0,0] row_mask:0xf bank_mask:0xf
  v_add_f32_dpp v72, v57, v72 quad_perm:[1,1,1,1] row_mask:0xf bank_mask:0xf
  v_add_f32_dpp v72, v58, v72 quad_perm:[2,2,2,2] row_mask:0xf bank_mask:0xf
  v_add_f32_dpp v72, v59, v72 quad_perm:[3,3,3,3] row_mask:0xf bank_mask:0xf
  v_mov_b32_dpp v73, v60 quad_perm:[0,0,0,0] row_mask:0xf bank_mask:0xf
  v_add_f32_dpp v73, v61, v73 quad_perm:[1,1,1,1] row_mask:0xf bank_mask:0xf
  v_add_f32_dpp v73, v62, v73 quad_perm:[2,2,2,2] row_mask:0xf bank_mask:0xf
  v_add_f32_dpp v73, v63, v73 quad_perm:[3,3,3,3] row_mask:0xf bank_mask:0xf
  v_mov_b32_dpp v74, v64 quad_perm:[0,0,0,0] row_mask:0xf bank_mask:0xf
  v_add_f32_dpp v74, v65, v74 quad_perm:[1,1,1,1] row_mask:0xf bank_mask:0xf
  v_add_f32_dpp v74, v66, v74 quad_perm:[2,2,2,2] row_mask:0xf bank_mask:0xf
  v_add_f32_dpp v74, v67, v74 quad_perm:[3,3,3,3] row_mask:0xf bank_mask:0xf
  v_mov_b32_dpp v75, v68 quad_perm:[0,0,0,0] row_mask:0xf bank_mask:0xf
  v_add_f32_dpp v75, v69, v75 quad_perm:[1,1,1,1] row_mask:0xf bank_mask:0xf
  v_add_f32_dpp v75, v70, v75 quad_perm:[2,2,2,2] row_mask:0xf bank_mask:0xf
  v_add_f32_dpp v75, v71, v75 quad_perm:[3,3,3,3] row_mask:0xf bank_mask:0xf
  ds_write_b128 v1, v[72:75] offset:1536
  v_max3_f32 v11, v11, v72, v73
  v_max3_f32 v11, v11, v74, v75
  v_mfma_f32_16x16x32_bf16 v[56:59], v[240:243], v[32:35], 0
  s_bitcmp1_b32 s33, 4
  s_cbranch_scc1 L_t61
  s_bitcmp0_b32 s33, 12
  s_cbranch_scc1 L_u61
  s_waitcnt vmcnt(3)
L_u61:
  s_waitcnt vmcnt(4)
L_t61:
  s_waitcnt vmcnt(6)
  s_xor_b32 s44, s44, 0x200000
  buffer_load_dwordx4 v[240:243], v36, s[36:39], s44 offen offset:0 nt
  v_mfma_f32_16x16x32_bf16 v[60:63], v[244:247], v[32:35], 0
  s_bitcmp1_b32 s33, 5
  s_cbranch_scc1 L_t62
  s_bitcmp0_b32 s33, 13
  s_cbranch_scc1 L_u62
  s_waitcnt vmcnt(3)
L_u62:
  s_waitcnt vmcnt(4)
L_t62:
  s_waitcnt vmcnt(6)
  buffer_load_dwordx4 v[244:247], v36, s[36:39], s44 offen offset:1024 nt
  v_mfma_f32_16x16x32_bf16 v[64:67], v[248:251], v[32:35], 0
  s_bitcmp1_b32 s33, 6
  s_cbranch_scc1 L_t63
  s_bitcmp0_b32 s33, 14
  s_cbranch_scc1 L_u63
  s_waitcnt vmcnt(3)
L_u63:
  s_waitcnt vmcnt(4)
L_t63:
  s_waitcnt vmcnt(6)
  buffer_load_dwordx4 v[248:251], v36, s[36:39], s44 offen offset:2048 nt
  v_mfma_f32_16x16x32_bf16 v[68:71], v[252:255], v[32:35], 0
  s_bitcmp1_b32 s33, 7
  s_cbranch_scc1 L_t64
  s_bitcmp0_b32 s33, 15
  s_cbranch_scc1 L_u64
  s_waitcnt vmcnt(3)
L_u64:
  s_waitcnt vmcnt(4)
L_t64:
  s_waitcnt vmcnt(6)
  buffer_load_dwordx4 v[252:255], v36, s[36:39], s44 offen offset:3072 nt
  s_sub_u32 s44, s44, s45
  s_and_b32 s44, s44, s45
  v_mov_b32_dpp v72, v56 quad_perm:[0,0,0,0] row_mask:0xf bank_mask:0xf
  v_add_f32_dpp v72, v57, v72 quad_perm:[1,1,1,1] row_mask:0xf bank_mask:0xf
  v_add_f32_dpp v72, v58, v72 quad_perm:[2,2,2,2] row_mask:0xf bank_mask:0xf
  v_add_f32_dpp v72, v59, v72 quad_perm:[3,3,3,3] row_mask:0xf bank_mask:0xf
  v_mov_b32_dpp v73, v60 quad_perm:[0,0,0,0] row_mask:0xf bank_mask:0xf
  v_add_f32_dpp v73, v61, v73 quad_perm:[1,1,1,1] row_mask:0xf bank_mask:0xf
  v_add_f32_dpp v73, v62, v73 quad_perm:[2,2,2,2] row_mask:0xf bank_mask:0xf
  v_add_f32_dpp v73, v63, v73 quad_perm:[3,3,3,3] row_mask:0xf bank_mask:0xf
  v_mov_b32_dpp v74, v64 quad_perm:[0,0,0,0] row_mask:0xf bank_mask:0xf
  v_add_f32_dpp v74, v65, v74 quad_perm:[1,1,1,1] row_mask:0xf bank_mask:0xf
  v_add_f32_dpp v74, v66, v74 quad_perm:[2,2,2,2] row_mask:0xf bank_mask:0xf
  v_add_f32_dpp v74, v67, v74 quad_perm:[3,3,3,3] row_mask:0xf bank_mask:0xf
  v_mov_b32_dpp v75, v68 quad_perm:[0,0,0,0] row_mask:0xf bank_mask:0xf
  v_add_f32_dpp v75, v69, v75 quad_perm:[1,1,1,1] row_mask:0xf bank_mask:0xf
  v_add_f32_dpp v75, v70, v75 quad_perm:[2,2,2,2] row_mask:0xf bank_mask:0xf
  v_add_f32_dpp v75, v71, v75 quad_perm:[3,3,3,3] row_mask:0xf bank_mask:0xf
  ds_write_b128 v1, v[72:75] offset:1792
  v_max3_f32 v11, v11, v72, v73
  v_max3_f32 v11, v11, v74, v75
  v_add_u32 v1, 2048, v1
  s_sub_u32 s47, s47, 1
  s_cmp_lg_u32 s47, 0
  s_cbranch_scc1 L_kg
  ds_read_b128 v[76:79], v39
  v_mov_b32 v1, v39
  v_mov_b32 v89, v11
  s_nop 1
  v_permlane16_swap_b32 v11, v89
  s_nop 1
  v_max_f32 v11, v11, v89
  v_mov_b32 v89, v11
  s_nop 1
  v_permlane32_swap_b32 v11, v89
  s_nop 1
  v_max_f32 v11, v11, v89
  v_mul_f32 v12, s48, v11
  s_mov_b32 s47, 2
L_vg:
  s_cmp_lg_u32 s47, 1
  s_cbranch_scc1 L_vg_go
  s_add_u32 s36, s8, s40
  s_addc_u32 s37, s9, 0
  v_mov_b32 v36, v3
  s_mov_b32 s44, s49
  s_mov_b32 s45, 0x1f0000
L_vg_go:
  s_waitcnt lgkmcnt(0)
  v_readfirstlane_b32 s33, v90
  v_readfirstlane_b32 s50, v91
  ds_read_b32 v90, v14 offset:12
  ds_add_rtn_u32 v91, v14, v15 offset:8
  s_sub_i32 s50, s50, s34
  s_addk_i32 s34, 256
  s_cmp_lt_i32 s50, 64
  s_cselect_b32 s51, 0x700, 0
  s_or_b32 s33, s33, s51
  s_cmp_ge_i32 s50, 192
  s_cselect_b32 s51, 0x7, 0
  s_or_b32 s33, s33, s51
  ds_read_b128 v[80:83], v1 offset:256
  v_fma_f32 v76, v76, s48, -v12
  v_fma_f32 v77, v77, s48, -v12
  v_fma_f32 v78, v78, s48, -v12
  v_fma_f32 v79, v79, s48, -v12
  v_exp_f32 v76, v76
  v_exp_f32 v77, v77
  v_exp_f32 v78, v78
  v_exp_f32 v79, v79
  v_cvt_pk_bf16_f32 v97, v76, v76
  v_cvt_pk_bf16_f32 v99, v77, v77
  v_cvt_pk_bf16_f32 v101, v78, v78
  v_cvt_pk_bf16_f32 v103, v79, v79
  v_and_b32 v96, v97, v4
  v_and_b32 v97, v97, v5
  v_and_b32 v98, v99, v4
  v_and_b32 v99, v99, v5
  v_and_b32 v100, v101, v4
  v_and_b32 v101, v101, v5
  v_and_b32 v102, v103, v4
  v_and_b32 v103, v103, v5
  v_add_f32 v13, v13, v76
  v_add_f32 v13, v13, v77
  v_add_f32 v13, v13, v78
  v_add_f32 v13, v13, v79
  v_mfma_f32_16x16x16_bf16 v[48:51], v[96:97], v[128:129], v[48:51]
  v_mfma_f32_16x16x16_bf16 v[52:55], v[96:97], v[130:131], v[52:55]
  s_bitcmp1_b32 s33, 0
  s_cbranch_scc1 L_t65
  s_bitcmp0_b32 s33, 8
  s_cbranch_scc1 L_u65
  s_waitcnt vmcnt(3)
L_u65:
  s_waitcnt vmcnt(4)
L_t65:
  s_waitcnt vmcnt(6)
  buffer_load_dwordx4 v[128:131], v36, s[36:39], s44 offen offset:0 nt
  v_mfma_f32_16x16x16_bf16 v[48:51], v[98:99], v[132:133], v[48:51]
  v_mfma_f32_16x16x16_bf16 v[52:55], v[98:99], v[134:135], v[52:55]
  s_bitcmp1_b32 s33, 1
  s_cbranch_scc1 L_t66
  s_bitcmp0_b32 s33, 9
  s_cbranch_scc1 L_u66
  s_waitcnt vmcnt(3)
L_u66:
  s_waitcnt vmcnt(4)
L_t66:
  s_waitcnt vmcnt(6)
  buffer_load_dwordx4 v[132:135], v36, s[36:39], s44 offen offset:1024 nt
  v_mfma_f32_16x16x16_bf16 v[48:51], v[100:101], v[136:137], v[48:51]
  v_mfma_f32_16x16x16_bf16 v[52:55], v[100:101], v[138:139], v[52:55]
  s_bitcmp1_b32 s33, 2
  s_cbranch_scc1 L_t67
  s_bitcmp0_b32 s33, 10
  s_cbranch_scc1 L_u67
  s_waitcnt vmcnt(3)
L_u67:
  s_waitcnt vmcnt(4)
L_t67:
  s_waitcnt vmcnt(6)
  buffer_load_dwordx4 v[136:139], v36, s[36:39], s44 offen offset:2048 nt
  v_mfma_f32_16x16x16_bf16 v[48:51], v[102:103], v[140:141], v[48:51]
  v_mfma_f32_16x16x16_bf16 v[52:55], v[102:103], v[142:143], v[52:55]
  s_bitcmp1_b32 s33, 3
  s_cbranch_scc1 L_t68
  s_bitcmp0_b32 s33, 11
  s_cbranch_scc1 L_u68
  s_waitcnt vmcnt(3)
L_u68:
  s_waitcnt vmcnt(4)
L_t68:
  s_waitcnt vmcnt(6)
  buffer_load_dwordx4 v[140:143], v36, s[36:39], s44 offen offset:3072 nt
  s_waitcnt lgkmcnt(0)
  ds_read_b128 v[76:79], v1 offset:512
  v_fma_f32 v80, v80, s48, -v12
  v_fma_f32 v81, v81, s48, -v12
  v_fma_f32 v82, v82, s48, -v12
  v_fma_f32 v83, v83, s48, -v12
  v_exp_f32 v80, v80
  v_exp_f32 v81, v81
  v_exp_f32 v82, v82
  v_exp_f32 v83, v83
  v_cvt_pk_bf16_f32 v97, v80, v80
  v_cvt_pk_bf16_f32 v99, v81, v81
  v_cvt_pk_bf16_f32 v101, v82, v82
  v_cvt_pk_bf16_f32 v103, v83, v83
  v_and_b32 v96, v97, v4
  v_and_b32 v97, v97, v5
  v_and_b32 v98, v99, v4
  v_and_b32 v99, v99, v5
  v_and_b32 v100, v101, v4
  v_and_b32 v101, v101, v5
  v_and_b32 v102, v103, v4
  v_and_b32 v103, v103, v5
  v_add_f32 v13, v13, v80
  v_add_f32 v13, v13, v81
  v_add_f32 v13, v13, v82
  v_add_f32 v13, v13, v83
  v_mfma_f32_16x16x16_bf16 v[48:51], v[96:97], v[144:145], v[48:51]
  v_mfma_f32_16x16x16_bf16 v[52:55], v[96:97], v[146:147], v[52:55]
  s_bitcmp1_b32 s33, 4
  s_cbranch_scc1 L_t69
  s_bitcmp0_b32 s33, 12
  s_cbranch_scc1 L_u69
  s_waitcnt vmcnt(3)
L_u69:
  s_waitcnt vmcnt(4)
L_t69:
  s_waitcnt vmcnt(6)
  s_xor_b32 s44, s44, 0x200000
  buffer_load_dwordx4 v[144:147], v36, s[36:39], s44 offen offset:0 nt
  v_mfma_f32_16x16x16_bf16 v[48:51], v[98:99], v[148:149], v[48:51]
  v_mfma_f32_16x16x16_bf16 v[52:55], v[98:99], v[150:151], v[52:55]
  s_bitcmp1_b32 s33, 5
  s_cbranch_scc1 L_t70
  s_bitcmp0_b32 s33, 13
  s_cbranch_scc1 L_u70
  s_waitcnt vmcnt(3)
L_u70:
  s_waitcnt vmcnt(4)
L_t70:
  s_waitcnt vmcnt(6)
  buffer_load_dwordx4 v[148:151], v36, s[36:39], s44 offen offset:1024 nt
  v_mfma_f32_16x16x16_bf16 v[48:51], v[100:101], v[152:153], v[48:51]
  v_mfma_f32_16x16x16_bf16 v[52:55], v[100:101], v[154:155], v[52:55]
  s_bitcmp1_b32 s33, 6
  s_cbranch_scc1 L_t71
  s_bitcmp0_b32 s33, 14
  s_cbranch_scc1 L_u71
  s_waitcnt vmcnt(3)
L_u71:
  s_waitcnt vmcnt(4)
L_t71:
  s_waitcnt vmcnt(6)
  buffer_load_dwordx4 v[152:155], v36, s[36:39], s44 offen offset:2048 nt
  v_mfma_f32_16x16x16_bf16 v[48:51], v[102:103], v[156:157], v[48:51]
  v_mfma_f32_16x16x16_bf16 v[52:55], v[102:103], v[158:159], v[52:55]
  s_bitcmp1_b32 s33, 7
  s_cbranch_scc1 L_t72
  s_bitcmp0_b32 s33, 15
  s_cbranch_scc1 L_u72
  s_waitcnt vmcnt(3)
L_u72:
  s_waitcnt vmcnt(4)
L_t72:
  s_waitcnt vmcnt(6)
  buffer_load_dwordx4 v[156:159], v36, s[36:39], s44 offen offset:3072 nt
  s_sub_u32 s44, s44, s45
  s_and_b32 s44, s44, s45
  s_waitcnt lgkmcnt(0)
  v_readfirstlane_b32 s33, v90
  v_readfirstlane_b32 s50, v91
  ds_read_b32 v90, v14 offset:12
  ds_add_rtn_u32 v91, v14, v15 offset:8
  s_sub_i32 s50, s50, s34
  s_addk_i32 s34, 256
  s_cmp_lt_i32 s50, 64
  s_cselect_b32 s51, 0x700, 0
  s_or_b32 s33, s33, s51
  s_cmp_ge_i32 s50, 192
  s_cselect_b32 s51, 0x7, 0
  s_or_b32 s33, s33, s51
  ds_read_b128 v[80:83], v1 offset:768
  v_fma_f32 v76, v76, s48, -v12
  v_fma_f32 v77, v77, s48, -v12
  v_fma_f32 v78, v78, s48, -v12
  v_fma_f32 v79, v79, s48, -v12
  v_exp_f32 v76, v76
  v_exp_f32 v77, v77
  v_exp_f32 v78, v78
  v_exp_f32 v79, v79
  v_cvt_pk_bf16_f32 v97, v76, v76
  v_cvt_pk_bf16_f32 v99, v77, v77
  v_cvt_pk_bf16_f32 v101, v78, v78
  v_cvt_pk_bf16_f32 v103, v79, v79
  v_and_b32 v96, v97, v4
  v_and_b32 v97, v97, v5
  v_and_b32 v98, v99, v4
  v_and_b32 v99, v99, v5
  v_and_b32 v100, v101, v4
  v_and_b32 v101, v101, v5
  v_and_b32 v102, v103, v4
  v_and_b32 v103, v103, v5
  v_add_f32 v13, v13, v76
  v_add_f32 v13, v13, v77
  v_add_f32 v13, v13, v78
  v_add_f32 v13, v13, v79
  v_mfma_f32_16x16x16_bf16 v[48:51], v[96:97], v[160:161], v[48:51]
  v_mfma_f32_16x16x16_bf16 v[52:55], v[96:97], v[162:163], v[52:55]
  s_bitcmp1_b32 s33, 0
  s_cbranch_scc1 L_t73
  s_bitcmp0_b32 s33, 8
  s_cbranch_scc1 L_u73
  s_waitcnt vmcnt(3)
L_u73:
  s_waitcnt vmcnt(4)
L_t73:
  s_waitcnt vmcnt(6)
  buffer_load_dwordx4 v[160:163], v36, s[36:39], s44 offen offset:0 nt
  v_mfma_f32_16x16x16_bf16 v[48:51], v[98:99], v[164:165], v[48:51]
  v_mfma_f32_16x16x16_bf16 v[52:55], v[98:99], v[166:167], v[52:55]
  s_bitcmp1_b32 s33, 1
  s_cbranch_scc1 L_t74
  s_bitcmp0_b32 s33, 9
  s_cbranch_scc1 L_u74
  s_waitcnt vmcnt(3)
L_u74:
  s_waitcnt vmcnt(4)
L_t74:
  s_waitcnt vmcnt(6)
  buffer_load_dwordx4 v[164:167], v36, s[36:39], s44 offen offset:1024 nt
  v_mfma_f32_16x16x16_bf16 v[48:51], v[100:101], v[168:169], v[48:51]
  v_mfma_f32_16x16x16_bf16 v[52:55], v[100:101], v[170:171], v[52:55]
  s_bitcmp1_b32 s33, 2
  s_cbranch_scc1 L_t75
  s_bitcmp0_b32 s33, 10
  s_cbranch_scc1 L_u75
  s_waitcnt vmcnt(3)
L_u75:
  s_waitcnt vmcnt(4)
L_t75:
  s_waitcnt vmcnt(6)
  buffer_load_dwordx4 v[168:171], v36, s[36:39], s44 offen offset:2048 nt
  v_mfma_f32_16x16x16_bf16 v[48:51], v[102:103], v[172:173], v[48:51]
  v_mfma_f32_16x16x16_bf16 v[52:55], v[102:103], v[174:175], v[52:55]
  s_bitcmp1_b32 s33, 3
  s_cbranch_scc1 L_t76
  s_bitcmp0_b32 s33, 11
  s_cbranch_scc1 L_u76
  s_waitcnt vmcnt(3)
L_u76:
  s_waitcnt vmcnt(4)
L_t76:
  s_waitcnt vmcnt(6)
  buffer_load_dwordx4 v[172:175], v36, s[36:39], s44 offen offset:3072 nt
  s_waitcnt lgkmcnt(0)
  ds_read_b128 v[76:79], v1 offset:1024
  v_fma_f32 v80, v80, s48, -v12
  v_fma_f32 v81, v81, s48, -v12
  v_fma_f32 v82, v82, s48, -v12
  v_fma_f32 v83, v83, s48, -v12
  v_exp_f32 v80, v80
  v_exp_f32 v81, v81
  v_exp_f32 v82, v82
  v_exp_f32 v83, v83
  v_cvt_pk_bf16_f32 v97, v80, v80
  v_cvt_pk_bf16_f32 v99, v81, v81
  v_cvt_pk_bf16_f32 v101, v82, v82
  v_cvt_pk_bf16_f32 v103, v83, v83
  v_and_b32 v96, v97, v4
  v_and_b32 v97, v97, v5
  v_and_b32 v98, v99, v4
  v_and_b32 v99, v99, v5
  v_and_b32 v100, v101, v4
  v_and_b32 v101, v101, v5
  v_and_b32 v102, v103, v4
  v_and_b32 v103, v103, v5
  v_add_f32 v13, v13, v80
  v_add_f32 v13, v13, v81
  v_add_f32 v13, v13, v82
  v_add_f32 v13, v13, v83
  v_mfma_f32_16x16x16_bf16 v[48:51], v[96:97], v[176:177], v[48:51]
  v_mfma_f32_16x16x16_bf16 v[52:55], v[96:97], v[178:179], v[52:55]
  s_bitcmp1_b32 s33, 4
  s_cbranch_scc1 L_t77
  s_bitcmp0_b32 s33, 12
  s_cbranch_scc1 L_u77
  s_waitcnt vmcnt(3)
L_u77:
  s_waitcnt vmcnt(4)
L_t77:
  s_waitcnt vmcnt(6)
  s_xor_b32 s44, s44, 0x200000
  buffer_load_dwordx4 v[176:179], v36, s[36:39], s44 offen offset:0 nt
  v_mfma_f32_16x16x16_bf16 v[48:51], v[98:99], v[180:181], v[48:51]
  v_mfma_f32_16x16x16_bf16 v[52:55], v[98:99], v[182:183], v[52:55]
  s_bitcmp1_b32 s33, 5
  s_cbranch_scc1 L_t78
  s_bitcmp0_b32 s33, 13
  s_cbranch_scc1 L_u78
  s_waitcnt vmcnt(3)
L_u78:
  s_waitcnt vmcnt(4)
L_t78:
  s_waitcnt vmcnt(6)
  buffer_load_dwordx4 v[180:183], v36, s[36:39], s44 offen offset:1024 nt
  v_mfma_f32_16x16x16_bf16 v[48:51], v[100:101], v[184:185], v[48:51]
  v_mfma_f32_16x16x16_bf16 v[52:55], v[100:101], v[186:187], v[52:55]
  s_bitcmp1_b32 s33, 6
  s_cbranch_scc1 L_t79
  s_bitcmp0_b32 s33, 14
  s_cbranch_scc1 L_u79
  s_waitcnt vmcnt(3)
L_u79:
  s_waitcnt vmcnt(4)
L_t79:
  s_waitcnt vmcnt(6)
  buffer_load_dwordx4 v[184:187], v36, s[36:39], s44 offen offset:2048 nt
  v_mfma_f32_16x16x16_bf16 v[48:51], v[102:103], v[188:189], v[48:51]
  v_mfma_f32_16x16x16_bf16 v[52:55], v[102:103], v[190:191], v[52:55]
  s_bitcmp1_b32 s33, 7
  s_cbranch_scc1 L_t80
  s_bitcmp0_b32 s33, 15
  s_cbranch_scc1 L_u80
  s_waitcnt vmcnt(3)
L_u80:
  s_waitcnt vmcnt(4)
L_t80:
  s_waitcnt vmcnt(6)
  buffer_load_dwordx4 v[188:191], v36, s[36:39], s44 offen offset:3072 nt
  s_sub_u32 s44, s44, s45
  s_and_b32 s44, s44, s45
  s_waitcnt lgkmcnt(0)
  v_readfirstlane_b32 s33, v90
  v_readfirstlane_b32 s50, v91
  ds_read_b32 v90, v14 offset:12
  ds_add_rtn_u32 v91, v14, v15 offset:8
  s_sub_i32 s50, s50, s34
  s_addk_i32 s34, 256
  s_cmp_lt_i32 s50, 64
  s_cselect_b32 s51, 0x700, 0
  s_or_b32 s33, s33, s51
  s_cmp_ge_i32 s50, 192
  s_cselect_b32 s51, 0x7, 0
  s_or_b32 s33, s33, s51
  ds_read_b128 v[80:83], v1 offset:1280
  v_fma_f32 v76, v76, s48, -v12
  v_fma_f32 v77, v77, s48, -v12
  v_fma_f32 v78, v78, s48, -v12
  v_fma_f32 v79, v79, s48, -v12
  v_exp_f32 v76, v76
  v_exp_f32 v77, v77
  v_exp_f32 v78, v78
  v_exp_f32 v79, v79
  v_cvt_pk_bf16_f32 v97, v76, v76
  v_cvt_pk_bf16_f32 v99, v77, v77
  v_cvt_pk_bf16_f32 v101, v78, v78
  v_cvt_pk_bf16_f32 v103, v79, v79
  v_and_b32 v96, v97, v4
  v_and_b32 v97, v97, v5
  v_and_b32 v98, v99, v4
  v_and_b32 v99, v99, v5
  v_and_b32 v100, v101, v4
  v_and_b32 v101, v101, v5
  v_and_b32 v102, v103, v4
  v_and_b32 v103, v103, v5
  v_add_f32 v13, v13, v76
  v_add_f32 v13, v13, v77
  v_add_f32 v13, v13, v78
  v_add_f32 v13, v13, v79
  v_mfma_f32_16x16x16_bf16 v[48:51], v[96:97], v[192:193], v[48:51]
  v_mfma_f32_16x16x16_bf16 v[52:55], v[96:97], v[194:195], v[52:55]
  s_bitcmp1_b32 s33, 0
  s_cbranch_scc1 L_t81
  s_bitcmp0_b32 s33, 8
  s_cbranch_scc1 L_u81
  s_waitcnt vmcnt(3)
L_u81:
  s_waitcnt vmcnt(4)
L_t81:
  s_waitcnt vmcnt(6)
  buffer_load_dwordx4 v[192:195], v36, s[36:39], s44 offen offset:0 nt
  v_mfma_f32_16x16x16_bf16 v[48:51], v[98:99], v[196:197], v[48:51]
  v_mfma_f32_16x16x16_bf16 v[52:55], v[98:99], v[198:199], v[52:55]
  s_bitcmp1_b32 s33, 1
  s_cbranch_scc1 L_t82
  s_bitcmp0_b32 s33, 9
  s_cbranch_scc1 L_u82
  s_waitcnt vmcnt(3)
L_u82:
  s_waitcnt vmcnt(4)
L_t82:
  s_waitcnt vmcnt(6)
  buffer_load_dwordx4 v[196:199], v36, s[36:39], s44 offen offset:1024 nt
  v_mfma_f32_16x16x16_bf16 v[48:51], v[100:101], v[200:201], v[48:51]
  v_mfma_f32_16x16x16_bf16 v[52:55], v[100:101], v[202:203], v[52:55]
  s_bitcmp1_b32 s33, 2
  s_cbranch_scc1 L_t83
  s_bitcmp0_b32 s33, 10
  s_cbranch_scc1 L_u83
  s_waitcnt vmcnt(3)
L_u83:
  s_waitcnt vmcnt(4)
L_t83:
  s_waitcnt vmcnt(6)
  buffer_load_dwordx4 v[200:203], v36, s[36:39], s44 offen offset:2048 nt
  v_mfma_f32_16x16x16_bf16 v[48:51], v[102:103], v[204:205], v[48:51]
  v_mfma_f32_16x16x16_bf16 v[52:55], v[102:103], v[206:207], v[52:55]
  s_bitcmp1_b32 s33, 3
  s_cbranch_scc1 L_t84
  s_bitcmp0_b32 s33, 11
  s_cbranch_scc1 L_u84
  s_waitcnt vmcnt(3)
L_u84:
  s_waitcnt vmcnt(4)
L_t84:
  s_waitcnt vmcnt(6)
  buffer_load_dwordx4 v[204:207], v36, s[36:39], s44 offen offset:3072 nt
  s_waitcnt lgkmcnt(0)
  ds_read_b128 v[76:79], v1 offset:1536
  v_fma_f32 v80, v80, s48, -v12
  v_fma_f32 v81, v81, s48, -v12
  v_fma_f32 v82, v82, s48, -v12
  v_fma_f32 v83, v83, s48, -v12
  v_exp_f32 v80, v80
  v_exp_f32 v81, v81
  v_exp_f32 v82, v82
  v_exp_f32 v83, v83
  v_cvt_pk_bf16_f32 v97, v80, v80
  v_cvt_pk_bf16_f32 v99, v81, v81
  v_cvt_pk_bf16_f32 v101, v82, v82
  v_cvt_pk_bf16_f32 v103, v83, v83
  v_and_b32 v96, v97, v4
  v_and_b32 v97, v97, v5
  v_and_b32 v98, v99, v4
  v_and_b32 v99, v99, v5
  v_and_b32 v100, v101, v4
  v_and_b32 v101, v101, v5
  v_and_b32 v102, v103, v4
  v_and_b32 v103, v103, v5
  v_add_f32 v13, v13, v80
  v_add_f32 v13, v13, v81
  v_add_f32 v13, v13, v82
  v_add_f32 v13, v13, v83
  v_mfma_f32_16x16x16_bf16 v[48:51], v[96:97], v[208:209], v[48:51]
  v_mfma_f32_16x16x16_bf16 v[52:55], v[96:97], v[210:211], v[52:55]
  s_bitcmp1_b32 s33, 4
  s_cbranch_scc1 L_t85
  s_bitcmp0_b32 s33, 12
  s_cbranch_scc1 L_u85
  s_waitcnt vmcnt(3)
L_u85:
  s_waitcnt vmcnt(4)
L_t85:
  s_waitcnt vmcnt(6)
  s_xor_b32 s44, s44, 0x200000
  buffer_load_dwordx4 v[208:211], v36, s[36:39], s44 offen offset:0 nt
  v_mfma_f32_16x16x16_bf16 v[48:51], v[98:99], v[212:213], v[48:51]
  v_mfma_f32_16x16x16_bf16 v[52:55], v[98:99], v[214:215], v[52:55]
  s_bitcmp1_b32 s33, 5
  s_cbranch_scc1 L_t86
  s_bitcmp0_b32 s33, 13
  s_cbranch_scc1 L_u86
  s_waitcnt vmcnt(3)
L_u86:
  s_waitcnt vmcnt(4)
L_t86:
  s_waitcnt vmcnt(6)
  buffer_load_dwordx4 v[212:215], v36, s[36:39], s44 offen offset:1024 nt
  v_mfma_f32_16x16x16_bf16 v[48:51], v[100:101], v[216:217], v[48:51]
  v_mfma_f32_16x16x16_bf16 v[52:55], v[100:101], v[218:219], v[52:55]
  s_bitcmp1_b32 s33, 6
  s_cbranch_scc1 L_t87
  s_bitcmp0_b32 s33, 14
  s_cbranch_scc1 L_u87
  s_waitcnt vmcnt(3)
L_u87:
  s_waitcnt vmcnt(4)
L_t87:
  s_waitcnt vmcnt(6)
  buffer_load_dwordx4 v[216:219], v36, s[36:39], s44 offen offset:2048 nt
  v_mfma_f32_16x16x16_bf16 v[48:51], v[102:103], v[220:221], v[48:51]
  v_mfma_f32_16x16x16_bf16 v[52:55], v[102:103], v[222:223], v[52:55]
  s_bitcmp1_b32 s33, 7
  s_cbranch_scc1 L_t88
  s_bitcmp0_b32 s33, 15
  s_cbranch_scc1 L_u88
  s_waitcnt vmcnt(3)
L_u88:
  s_waitcnt vmcnt(4)
L_t88:
  s_waitcnt vmcnt(6)
  buffer_load_dwordx4 v[220:223], v36, s[36:39], s44 offen offset:3072 nt
  s_sub_u32 s44, s44, s45
  s_and_b32 s44, s44, s45
  s_waitcnt lgkmcnt(0)
  v_readfirstlane_b32 s33, v90
  v_readfirstlane_b32 s50, v91
  ds_read_b32 v90, v14 offset:12
  ds_add_rtn_u32 v91, v14, v15 offset:8
  s_sub_i32 s50, s50, s34
  s_addk_i32 s34, 256
  s_cmp_lt_i32 s50, 64
  s_cselect_b32 s51, 0x700, 0
  s_or_b32 s33, s33, s51
  s_cmp_ge_i32 s50, 192
  s_cselect_b32 s51, 0x7, 0
  s_or_b32 s33, s33, s51
  ds_read_b128 v[80:83], v1 offset:1792
  v_fma_f32 v76, v76, s48, -v12
  v_fma_f32 v77, v77, s48, -v12
  v_fma_f32 v78, v78, s48, -v12
  v_fma_f32 v79, v79, s48, -v12
  v_exp_f32 v76, v76
  v_exp_f32 v77, v77
  v_exp_f32 v78, v78
  v_exp_f32 v79, v79
  v_cvt_pk_bf16_f32 v97, v76, v76
  v_cvt_pk_bf16_f32 v99, v77, v77
  v_cvt_pk_bf16_f32 v101, v78, v78
  v_cvt_pk_bf16_f32 v103, v79, v79
  v_and_b32 v96, v97, v4
  v_and_b32 v97, v97, v5
  v_and_b32 v98, v99, v4
  v_and_b32 v99, v99, v5
  v_and_b32 v100, v101, v4
  v_and_b32 v101, v101, v5
  v_and_b32 v102, v103, v4
  v_and_b32 v103, v103, v5
  v_add_f32 v13, v13, v76
  v_add_f32 v13, v13, v77
  v_add_f32 v13, v13, v78
  v_add_f32 v13, v13, v79
  v_mfma_f32_16x16x16_bf16 v[48:51], v[96:97], v[224:225], v[48:51]
  v_mfma_f32_16x16x16_bf16 v[52:55], v[96:97], v[226:227], v[52:55]
  s_bitcmp1_b32 s33, 0
  s_cbranch_scc1 L_t89
  s_bitcmp0_b32 s33, 8
  s_cbranch_scc1 L_u89
  s_waitcnt vmcnt(3)
L_u89:
  s_waitcnt vmcnt(4)
L_t89:
  s_waitcnt vmcnt(6)
  buffer_load_dwordx4 v[224:227], v36, s[36:39], s44 offen offset:0 nt
  v_mfma_f32_16x16x16_bf16 v[48:51], v[98:99], v[228:229], v[48:51]
  v_mfma_f32_16x16x16_bf16 v[52:55], v[98:99], v[230:231], v[52:55]
  s_bitcmp1_b32 s33, 1
  s_cbranch_scc1 L_t90
  s_bitcmp0_b32 s33, 9
  s_cbranch_scc1 L_u90
  s_waitcnt vmcnt(3)
L_u90:
  s_waitcnt vmcnt(4)
L_t90:
  s_waitcnt vmcnt(6)
  buffer_load_dwordx4 v[228:231], v36, s[36:39], s44 offen offset:1024 nt
  v_mfma_f32_16x16x16_bf16 v[48:51], v[100:101], v[232:233], v[48:51]
  v_mfma_f32_16x16x16_bf16 v[52:55], v[100:101], v[234:235], v[52:55]
  s_bitcmp1_b32 s33, 2
  s_cbranch_scc1 L_t91
  s_bitcmp0_b32 s33, 10
  s_cbranch_scc1 L_u91
  s_waitcnt vmcnt(3)
L_u91:
  s_waitcnt vmcnt(4)
L_t91:
  s_waitcnt vmcnt(6)
  buffer_load_dwordx4 v[232:235], v36, s[36:39], s44 offen offset:2048 nt
  v_mfma_f32_16x16x16_bf16 v[48:51], v[102:103], v[236:237], v[48:51]
  v_mfma_f32_16x16x16_bf16 v[52:55], v[102:103], v[238:239], v[52:55]
  s_bitcmp1_b32 s33, 3
  s_cbranch_scc1 L_t92
  s_bitcmp0_b32 s33, 11
  s_cbranch_scc1 L_u92
  s_waitcnt vmcnt(3)
L_u92:
  s_waitcnt vmcnt(4)
L_t92:
  s_waitcnt vmcnt(6)
  buffer_load_dwordx4 v[236:239], v36, s[36:39], s44 offen offset:3072 nt
  s_waitcnt lgkmcnt(0)
  ds_read_b128 v[76:79], v1 offset:2048
  v_fma_f32 v80, v80, s48, -v12
  v_fma_f32 v81, v81, s48, -v12
  v_fma_f32 v82, v82, s48, -v12
  v_fma_f32 v83, v83, s48, -v12
  v_exp_f32 v80, v80
  v_exp_f32 v81, v81
  v_exp_f32 v82, v82
  v_exp_f32 v83, v83
  v_cvt_pk_bf16_f32 v97, v80, v80
  v_cvt_pk_bf16_f32 v99, v81, v81
  v_cvt_pk_bf16_f32 v101, v82, v82
  v_cvt_pk_bf16_f32 v103, v83, v83
  v_and_b32 v96, v97, v4
  v_and_b32 v97, v97, v5
  v_and_b32 v98, v99, v4
  v_and_b32 v99, v99, v5
  v_and_b32 v100, v101, v4
  v_and_b32 v101, v101, v5
  v_and_b32 v102, v103, v4
  v_and_b32 v103, v103, v5
  v_add_f32 v13, v13, v80
  v_add_f32 v13, v13, v81
  v_add_f32 v13, v13, v82
  v_add_f32 v13, v13, v83
  v_mfma_f32_16x16x16_bf16 v[48:51], v[96:97], v[240:241], v[48:51]
  v_mfma_f32_16x16x16_bf16 v[52:55], v[96:97], v[242:243], v[52:55]
  s_bitcmp1_b32 s33, 4
  s_cbranch_scc1 L_t93
  s_bitcmp0_b32 s33, 12
  s_cbranch_scc1 L_u93
  s_waitcnt vmcnt(3)
L_u93:
  s_waitcnt vmcnt(4)
L_t93:
  s_waitcnt vmcnt(6)
  s_xor_b32 s44, s44, 0x200000
  buffer_load_dwordx4 v[240:243], v36, s[36:39], s44 offen offset:0 nt
  v_mfma_f32_16x16x16_bf16 v[48:51], v[98:99], v[244:245], v[48:51]
  v_mfma_f32_16x16x16_bf16 v[52:55], v[98:99], v[246:247], v[52:55]
  s_bitcmp1_b32 s33, 5
  s_cbranch_scc1 L_t94
  s_bitcmp0_b32 s33, 13
  s_cbranch_scc1 L_u94
  s_waitcnt vmcnt(3)
L_u94:
  s_waitcnt vmcnt(4)
L_t94:
  s_waitcnt vmcnt(6)
  buffer_load_dwordx4 v[244:247], v36, s[36:39], s44 offen offset:1024 nt
  v_mfma_f32_16x16x16_bf16 v[48:51], v[100:101], v[248:249], v[48:51]
  v_mfma_f32_16x16x16_bf16 v[52:55], v[100:101], v[250:251], v[52:55]
  s_bitcmp1_b32 s33, 6
  s_cbranch_scc1 L_t95
  s_bitcmp0_b32 s33, 14
  s_cbranch_scc1 L_u95
  s_waitcnt vmcnt(3)
L_u95:
  s_waitcnt vmcnt(4)
L_t95:
  s_waitcnt vmcnt(6)
  buffer_load_dwordx4 v[248:251], v36, s[36:39], s44 offen offset:2048 nt
  v_mfma_f32_16x16x16_bf16 v[48:51], v[102:103], v[252:253], v[48:51]
  v_mfma_f32_16x16x16_bf16 v[52:55], v[102:103], v[254:255], v[52:55]
  s_bitcmp1_b32 s33, 7
  s_cbranch_scc1 L_t96
  s_bitcmp0_b32 s33, 15
  s_cbranch_scc1 L_u96
  s_waitcnt vmcnt(3)
L_u96:
  s_waitcnt vmcnt(4)
L_t96:
  s_waitcnt vmcnt(6)
  buffer_load_dwordx4 v[252:255], v36, s[36:39], s44 offen offset:3072 nt
  s_sub_u32 s44, s44, s45
  s_and_b32 s44, s44, s45
  v_add_u32 v1, 2048, v1
  s_sub_u32 s47, s47, 1
  s_cmp_lg_u32 s47, 0
  s_cbranch_scc1 L_vg
  s_mul_i32 s50, s3, 2560
  s_add_u32 s50, s50, 6144
  v_lshl_add_u32 v6, v0, 5, s50
  v_lshl_add_u32 v7, v0, 2, s50
  ds_write_b128 v6, v[48:51]
  ds_write_b128 v6, v[52:55] offset:16
  ds_write_b32 v7, v12 offset:2048
  ds_write_b32 v7, v13 offset:2304
  ds_add_u32 v14, v15 offset:4
  ds_read_b128 v[76:79], v38
  v_mov_b32 v1, v38
  v_max_f32_dpp v8, v8, v8 row_ror:4 row_mask:0xf bank_mask:0xf
  s_nop 1
  v_max_f32_dpp v8, v8, v8 row_ror:8 row_mask:0xf bank_mask:0xf
  v_mov_b32 v89, v8
  s_nop 1
  v_permlane16_swap_b32 v8, v89
  s_nop 1
  v_max_f32 v8, v8, v89
  v_mov_b32 v89, v8
  s_nop 1
  v_permlane32_swap_b32 v8, v89
  s_nop 1
  v_max_f32 v8, v8, v89
  v_mul_f32 v9, s48, v8
  s_mov_b32 s47, 6
L_vm:
  s_waitcnt lgkmcnt(0)
  v_readfirstlane_b32 s33, v90
  v_readfirstlane_b32 s50, v91
  ds_read_b32 v90, v14 offset:12
  ds_add_rtn_u32 v91, v14, v15 offset:8
  s_sub_i32 s50, s50, s34
  s_addk_i32 s34, 256
  s_cmp_lt_i32 s50, 64
  s_cselect_b32 s51, 0x700, 0
  s_or_b32 s33, s33, s51
  s_cmp_ge_i32 s50, 192
  s_cselect_b32 s51, 0x7, 0
  s_or_b32 s33, s33, s51
  ds_read_b128 v[80:83], v1 offset:64
  v_fma_f32 v76, v76, s48, -v9
  v_fma_f32 v77, v77, s48, -v9
  v_fma_f32 v78, v78, s48, -v9
  v_fma_f32 v79, v79, s48, -v9
  v_exp_f32 v76, v76
  v_exp_f32 v77, v77
  v_exp_f32 v78, v78
  v_exp_f32 v79, v79
  v_cvt_pk_bf16_f32 v97, v76, v76
  v_cvt_pk_bf16_f32 v99, v77, v77
  v_cvt_pk_bf16_f32 v101, v78, v78
  v_cvt_pk_bf16_f32 v103, v79, v79
  v_and_b32 v96, v97, v4
  v_and_b32 v97, v97, v5
  v_and_b32 v98, v99, v4
  v_and_b32 v99, v99, v5
  v_and_b32 v100, v101, v4
  v_and_b32 v101, v101, v5
  v_and_b32 v102, v103, v4
  v_and_b32 v103, v103, v5
  v_add_f32 v10, v10, v76
  v_add_f32 v10, v10, v77
  v_add_f32 v10, v10, v78
  v_add_f32 v10, v10, v79
  v_mfma_f32_16x16x16_bf16 v[40:43], v[96:97], v[128:129], v[40:43]
  v_mfma_f32_16x16x16_bf16 v[44:47], v[96:97], v[130:131], v[44:47]
  s_bitcmp1_b32 s33, 0
  s_cbranch_scc1 L_t97
  s_bitcmp0_b32 s33, 8
  s_cbranch_scc1 L_u97
  s_waitcnt vmcnt(3)
L_u97:
  s_waitcnt vmcnt(4)
L_t97:
  s_waitcnt vmcnt(6)
  buffer_load_dwordx4 v[128:131], v36, s[36:39], s44 offen offset:0 nt
  v_mfma_f32_16x16x16_bf16 v[40:43], v[98:99], v[132:133], v[40:43]
  v_mfma_f32_16x16x16_bf16 v[44:47], v[98:99], v[134:135], v[44:47]
  s_bitcmp1_b32 s33, 1
  s_cbranch_scc1 L_t98
  s_bitcmp0_b32 s33, 9
  s_cbranch_scc1 L_u98
  s_waitcnt vmcnt(3)
L_u98:
  s_waitcnt vmcnt(4)
L_t98:
  s_waitcnt vmcnt(6)
  buffer_load_dwordx4 v[132:135], v36, s[36:39], s44 offen offset:1024 nt
  v_mfma_f32_16x16x16_bf16 v[40:43], v[100:101], v[136:137], v[40:43]
  v_mfma_f32_16x16x16_bf16 v[44:47], v[100:101], v[138:139], v[44:47]
  s_bitcmp1_b32 s33, 2
  s_cbranch_scc1 L_t99
  s_bitcmp0_b32 s33, 10
  s_cbranch_scc1 L_u99
  s_waitcnt vmcnt(3)
L_u99:
  s_waitcnt vmcnt(4)
L_t99:
  s_waitcnt vmcnt(6)
  buffer_load_dwordx4 v[136:139], v36, s[36:39], s44 offen offset:2048 nt
  v_mfma_f32_16x16x16_bf16 v[40:43], v[102:103], v[140:141], v[40:43]
  v_mfma_f32_16x16x16_bf16 v[44:47], v[102:103], v[142:143], v[44:47]
  s_bitcmp1_b32 s33, 3
  s_cbranch_scc1 L_t100
  s_bitcmp0_b32 s33, 11
  s_cbranch_scc1 L_u100
  s_waitcnt vmcnt(3)
L_u100:
  s_waitcnt vmcnt(4)
L_t100:
  s_waitcnt vmcnt(6)
  buffer_load_dwordx4 v[140:143], v36, s[36:39], s44 offen offset:3072 nt
  s_waitcnt lgkmcnt(0)
  ds_read_b128 v[76:79], v1 offset:128
  v_fma_f32 v80, v80, s48, -v9
  v_fma_f32 v81, v81, s48, -v9
  v_fma_f32 v82, v82, s48, -v9
  v_fma_f32 v83, v83, s48, -v9
  v_exp_f32 v80, v80
  v_exp_f32 v81, v81
  v_exp_f32 v82, v82
  v_exp_f32 v83, v83
  v_cvt_pk_bf16_f32 v97, v80, v80
  v_cvt_pk_bf16_f32 v99, v81, v81
  v_cvt_pk_bf16_f32 v101, v82, v82
  v_cvt_pk_bf16_f32 v103, v83, v83
  v_and_b32 v96, v97, v4
  v_and_b32 v97, v97, v5
  v_and_b32 v98, v99, v4
  v_and_b32 v99, v99, v5
  v_and_b32 v100, v101, v4
  v_and_b32 v101, v101, v5
  v_and_b32 v102, v103, v4
  v_and_b32 v103, v103, v5
  v_add_f32 v10, v10, v80
  v_add_f32 v10, v10, v81
  v_add_f32 v10, v10, v82
  v_add_f32 v10, v10, v83
  v_mfma_f32_16x16x16_bf16 v[40:43], v[96:97], v[144:145], v[40:43]
  v_mfma_f32_16x16x16_bf16 v[44:47], v[96:97], v[146:147], v[44:47]
  s_bitcmp1_b32 s33, 4
  s_cbranch_scc1 L_t101
  s_bitcmp0_b32 s33, 12
  s_cbranch_scc1 L_u101
  s_waitcnt vmcnt(3)
L_u101:
  s_waitcnt vmcnt(4)
L_t101:
  s_waitcnt vmcnt(6)
  s_xor_b32 s44, s44, 0x200000
  buffer_load_dwordx4 v[144:147], v36, s[36:39], s44 offen offset:0 nt
  v_mfma_f32_16x16x16_bf16 v[40:43], v[98:99], v[148:149], v[40:43]
  v_mfma_f32_16x16x16_bf16 v[44:47], v[98:99], v[150:151], v[44:47]
  s_bitcmp1_b32 s33, 5
  s_cbranch_scc1 L_t102
  s_bitcmp0_b32 s33, 13
  s_cbranch_scc1 L_u102
  s_waitcnt vmcnt(3)
L_u102:
  s_waitcnt vmcnt(4)
L_t102:
  s_waitcnt vmcnt(6)
  buffer_load_dwordx4 v[148:151], v36, s[36:39], s44 offen offset:1024 nt
  v_mfma_f32_16x16x16_bf16 v[40:43], v[100:101], v[152:153], v[40:43]
  v_mfma_f32_16x16x16_bf16 v[44:47], v[100:101], v[154:155], v[44:47]
  s_bitcmp1_b32 s33, 6
  s_cbranch_scc1 L_t103
  s_bitcmp0_b32 s33, 14
  s_cbranch_scc1 L_u103
  s_waitcnt vmcnt(3)
L_u103:
  s_waitcnt vmcnt(4)
L_t103:
  s_waitcnt vmcnt(6)
  buffer_load_dwordx4 v[152:155], v36, s[36:39], s44 offen offset:2048 nt
  v_mfma_f32_16x16x16_bf16 v[40:43], v[102:103], v[156:157], v[40:43]
  v_mfma_f32_16x16x16_bf16 v[44:47], v[102:103], v[158:159], v[44:47]
  s_bitcmp1_b32 s33, 7
  s_cbranch_scc1 L_t104
  s_bitcmp0_b32 s33, 15
  s_cbranch_scc1 L_u104
  s_waitcnt vmcnt(3)
L_u104:
  s_waitcnt vmcnt(4)
L_t104:
  s_waitcnt vmcnt(6)
  buffer_load_dwordx4 v[156:159], v36, s[36:39], s44 offen offset:3072 nt
  s_sub_u32 s44, s44, s45
  s_and_b32 s44, s44, s45
  s_waitcnt lgkmcnt(0)
  v_readfirstlane_b32 s33, v90
  v_readfirstlane_b32 s50, v91
  ds_read_b32 v90, v14 offset:12
  ds_add_rtn_u32 v91, v14, v15 offset:8
  s_sub_i32 s50, s50, s34
  s_addk_i32 s34, 256
  s_cmp_lt_i32 s50, 64
  s_cselect_b32 s51, 0x700, 0
  s_or_b32 s33, s33, s51
  s_cmp_ge_i32 s50, 192
  s_cselect_b32 s51, 0x7, 0
  s_or_b32 s33, s33, s51
  ds_read_b128 v[80:83], v1 offset:192
  v_fma_f32 v76, v76, s48, -v9
  v_fma_f32 v77, v77, s48, -v9
  v_fma_f32 v78, v78, s48, -v9
  v_fma_f32 v79, v79, s48, -v9
  v_exp_f32 v76, v76
  v_exp_f32 v77, v77
  v_exp_f32 v78, v78
  v_exp_f32 v79, v79
  v_cvt_pk_bf16_f32 v97, v76, v76
  v_cvt_pk_bf16_f32 v99, v77, v77
  v_cvt_pk_bf16_f32 v101, v78, v78
  v_cvt_pk_bf16_f32 v103, v79, v79
  v_and_b32 v96, v97, v4
  v_and_b32 v97, v97, v5
  v_and_b32 v98, v99, v4
  v_and_b32 v99, v99, v5
  v_and_b32 v100, v101, v4
  v_and_b32 v101, v101, v5
  v_and_b32 v102, v103, v4
  v_and_b32 v103, v103, v5
  v_add_f32 v10, v10, v76
  v_add_f32 v10, v10, v77
  v_add_f32 v10, v10, v78
  v_add_f32 v10, v10, v79
  v_mfma_f32_16x16x16_bf16 v[40:43], v[96:97], v[160:161], v[40:43]
  v_mfma_f32_16x16x16_bf16 v[44:47], v[96:97], v[162:163], v[44:47]
  s_bitcmp1_b32 s33, 0
  s_cbranch_scc1 L_t105
  s_bitcmp0_b32 s33, 8
  s_cbranch_scc1 L_u105
  s_waitcnt vmcnt(3)
L_u105:
  s_waitcnt vmcnt(4)
L_t105:
  s_waitcnt vmcnt(6)
  buffer_load_dwordx4 v[160:163], v36, s[36:39], s44 offen offset:0 nt
  v_mfma_f32_16x16x16_bf16 v[40:43], v[98:99], v[164:165], v[40:43]
  v_mfma_f32_16x16x16_bf16 v[44:47], v[98:99], v[166:167], v[44:47]
  s_bitcmp1_b32 s33, 1
  s_cbranch_scc1 L_t106
  s_bitcmp0_b32 s33, 9
  s_cbranch_scc1 L_u106
  s_waitcnt vmcnt(3)
L_u106:
  s_waitcnt vmcnt(4)
L_t106:
  s_waitcnt vmcnt(6)
  buffer_load_dwordx4 v[164:167], v36, s[36:39], s44 offen offset:1024 nt
  v_mfma_f32_16x16x16_bf16 v[40:43], v[100:101], v[168:169], v[40:43]
  v_mfma_f32_16x16x16_bf16 v[44:47], v[100:101], v[170:171], v[44:47]
  s_bitcmp1_b32 s33, 2
  s_cbranch_scc1 L_t107
  s_bitcmp0_b32 s33, 10
  s_cbranch_scc1 L_u107
  s_waitcnt vmcnt(3)
L_u107:
  s_waitcnt vmcnt(4)
L_t107:
  s_waitcnt vmcnt(6)
  buffer_load_dwordx4 v[168:171], v36, s[36:39], s44 offen offset:2048 nt
  v_mfma_f32_16x16x16_bf16 v[40:43], v[102:103], v[172:173], v[40:43]
  v_mfma_f32_16x16x16_bf16 v[44:47], v[102:103], v[174:175], v[44:47]
  s_bitcmp1_b32 s33, 3
  s_cbranch_scc1 L_t108
  s_bitcmp0_b32 s33, 11
  s_cbranch_scc1 L_u108
  s_waitcnt vmcnt(3)
L_u108:
  s_waitcnt vmcnt(4)
L_t108:
  s_waitcnt vmcnt(6)
  buffer_load_dwordx4 v[172:175], v36, s[36:39], s44 offen offset:3072 nt
  s_waitcnt lgkmcnt(0)
  ds_read_b128 v[76:79], v1 offset:256
  v_fma_f32 v80, v80, s48, -v9
  v_fma_f32 v81, v81, s48, -v9
  v_fma_f32 v82, v82, s48, -v9
  v_fma_f32 v83, v83, s48, -v9
  v_exp_f32 v80, v80
  v_exp_f32 v81, v81
  v_exp_f32 v82, v82
  v_exp_f32 v83, v83
  v_cvt_pk_bf16_f32 v97, v80, v80
  v_cvt_pk_bf16_f32 v99, v81, v81
  v_cvt_pk_bf16_f32 v101, v82, v82
  v_cvt_pk_bf16_f32 v103, v83, v83
  v_and_b32 v96, v97, v4
  v_and_b32 v97, v97, v5
  v_and_b32 v98, v99, v4
  v_and_b32 v99, v99, v5
  v_and_b32 v100, v101, v4
  v_and_b32 v101, v101, v5
  v_and_b32 v102, v103, v4
  v_and_b32 v103, v103, v5
  v_add_f32 v10, v10, v80
  v_add_f32 v10, v10, v81
  v_add_f32 v10, v10, v82
  v_add_f32 v10, v10, v83
  v_mfma_f32_16x16x16_bf16 v[40:43], v[96:97], v[176:177], v[40:43]
  v_mfma_f32_16x16x16_bf16 v[44:47], v[96:97], v[178:179], v[44:47]
  s_bitcmp1_b32 s33, 4
  s_cbranch_scc1 L_t109
  s_bitcmp0_b32 s33, 12
  s_cbranch_scc1 L_u109
  s_waitcnt vmcnt(3)
L_u109:
  s_waitcnt vmcnt(4)
L_t109:
  s_waitcnt vmcnt(6)
  s_xor_b32 s44, s44, 0x200000
  buffer_load_dwordx4 v[176:179], v36, s[36:39], s44 offen offset:0 nt
  v_mfma_f32_16x16x16_bf16 v[40:43], v[98:99], v[180:181], v[40:43]
  v_mfma_f32_16x16x16_bf16 v[44:47], v[98:99], v[182:183], v[44:47]
  s_bitcmp1_b32 s33, 5
  s_cbranch_scc1 L_t110
  s_bitcmp0_b32 s33, 13
  s_cbranch_scc1 L_u110
  s_waitcnt vmcnt(3)
L_u110:
  s_waitcnt vmcnt(4)
L_t110:
  s_waitcnt vmcnt(6)
  buffer_load_dwordx4 v[180:183], v36, s[36:39], s44 offen offset:1024 nt
  v_mfma_f32_16x16x16_bf16 v[40:43], v[100:101], v[184:185], v[40:43]
  v_mfma_f32_16x16x16_bf16 v[44:47], v[100:101], v[186:187], v[44:47]
  s_bitcmp1_b32 s33, 6
  s_cbranch_scc1 L_t111
  s_bitcmp0_b32 s33, 14
  s_cbranch_scc1 L_u111
  s_waitcnt vmcnt(3)
L_u111:
  s_waitcnt vmcnt(4)
L_t111:
  s_waitcnt vmcnt(6)
  buffer_load_dwordx4 v[184:187], v36, s[36:39], s44 offen offset:2048 nt
  v_mfma_f32_16x16x16_bf16 v[40:43], v[102:103], v[188:189], v[40:43]
  v_mfma_f32_16x16x16_bf16 v[44:47], v[102:103], v[190:191], v[44:47]
  s_bitcmp1_b32 s33, 7
  s_cbranch_scc1 L_t112
  s_bitcmp0_b32 s33, 15
  s_cbranch_scc1 L_u112
  s_waitcnt vmcnt(3)
L_u112:
  s_waitcnt vmcnt(4)
L_t112:
  s_waitcnt vmcnt(6)
  buffer_load_dwordx4 v[188:191], v36, s[36:39], s44 offen offset:3072 nt
  s_sub_u32 s44, s44, s45
  s_and_b32 s44, s44, s45
  s_waitcnt lgkmcnt(0)
  v_readfirstlane_b32 s33, v90
  v_readfirstlane_b32 s50, v91
  ds_read_b32 v90, v14 offset:12
  ds_add_rtn_u32 v91, v14, v15 offset:8
  s_sub_i32 s50, s50, s34
  s_addk_i32 s34, 256
  s_cmp_lt_i32 s50, 64
  s_cselect_b32 s51, 0x700, 0
  s_or_b32 s33, s33, s51
  s_cmp_ge_i32 s50, 192
  s_cselect_b32 s51, 0x7, 0
  s_or_b32 s33, s33, s51
  ds_read_b128 v[80:83], v1 offset:320
  v_fma_f32 v76, v76, s48, -v9
  v_fma_f32 v77, v77, s48, -v9
  v_fma_f32 v78, v78, s48, -v9
  v_fma_f32 v79, v79, s48, -v9
  v_exp_f32 v76, v76
  v_exp_f32 v77, v77
  v_exp_f32 v78, v78
  v_exp_f32 v79, v79
  v_cvt_pk_bf16_f32 v97, v76, v76
  v_cvt_pk_bf16_f32 v99, v77, v77
  v_cvt_pk_bf16_f32 v101, v78, v78
  v_cvt_pk_bf16_f32 v103, v79, v79
  v_and_b32 v96, v97, v4
  v_and_b32 v97, v97, v5
  v_and_b32 v98, v99, v4
  v_and_b32 v99, v99, v5
  v_and_b32 v100, v101, v4
  v_and_b32 v101, v101, v5
  v_and_b32 v102, v103, v4
  v_and_b32 v103, v103, v5
  v_add_f32 v10, v10, v76
  v_add_f32 v10, v10, v77
  v_add_f32 v10, v10, v78
  v_add_f32 v10, v10, v79
  v_mfma_f32_16x16x16_bf16 v[40:43], v[96:97], v[192:193], v[40:43]
  v_mfma_f32_16x16x16_bf16 v[44:47], v[96:97], v[194:195], v[44:47]
  s_bitcmp1_b32 s33, 0
  s_cbranch_scc1 L_t113
  s_bitcmp0_b32 s33, 8
  s_cbranch_scc1 L_u113
  s_waitcnt vmcnt(3)
L_u113:
  s_waitcnt vmcnt(4)
L_t113:
  s_waitcnt vmcnt(6)
  buffer_load_dwordx4 v[192:195], v36, s[36:39], s44 offen offset:0 nt
  v_mfma_f32_16x16x16_bf16 v[40:43], v[98:99], v[196:197], v[40:43]
  v_mfma_f32_16x16x16_bf16 v[44:47], v[98:99], v[198:199], v[44:47]
  s_bitcmp1_b32 s33, 1
  s_cbranch_scc1 L_t114
  s_bitcmp0_b32 s33, 9
  s_cbranch_scc1 L_u114
  s_waitcnt vmcnt(3)
L_u114:
  s_waitcnt vmcnt(4)
L_t114:
  s_waitcnt vmcnt(6)
  buffer_load_dwordx4 v[196:199], v36, s[36:39], s44 offen offset:1024 nt
  v_mfma_f32_16x16x16_bf16 v[40:43], v[100:101], v[200:201], v[40:43]
  v_mfma_f32_16x16x16_bf16 v[44:47], v[100:101], v[202:203], v[44:47]
  s_bitcmp1_b32 s33, 2
  s_cbranch_scc1 L_t115
  s_bitcmp0_b32 s33, 10
  s_cbranch_scc1 L_u115
  s_waitcnt vmcnt(3)
L_u115:
  s_waitcnt vmcnt(4)
L_t115:
  s_waitcnt vmcnt(6)
  buffer_load_dwordx4 v[200:203], v36, s[36:39], s44 offen offset:2048 nt
  v_mfma_f32_16x16x16_bf16 v[40:43], v[102:103], v[204:205], v[40:43]
  v_mfma_f32_16x16x16_bf16 v[44:47], v[102:103], v[206:207], v[44:47]
  s_bitcmp1_b32 s33, 3
  s_cbranch_scc1 L_t116
  s_bitcmp0_b32 s33, 11
  s_cbranch_scc1 L_u116
  s_waitcnt vmcnt(3)
L_u116:
  s_waitcnt vmcnt(4)
L_t116:
  s_waitcnt vmcnt(6)
  buffer_load_dwordx4 v[204:207], v36, s[36:39], s44 offen offset:3072 nt
  s_waitcnt lgkmcnt(0)
  ds_read_b128 v[76:79], v1 offset:384
  v_fma_f32 v80, v80, s48, -v9
  v_fma_f32 v81, v81, s48, -v9
  v_fma_f32 v82, v82, s48, -v9
  v_fma_f32 v83, v83, s48, -v9
  v_exp_f32 v80, v80
  v_exp_f32 v81, v81
  v_exp_f32 v82, v82
  v_exp_f32 v83, v83
  v_cvt_pk_bf16_f32 v97, v80, v80
  v_cvt_pk_bf16_f32 v99, v81, v81
  v_cvt_pk_bf16_f32 v101, v82, v82
  v_cvt_pk_bf16_f32 v103, v83, v83
  v_and_b32 v96, v97, v4
  v_and_b32 v97, v97, v5
  v_and_b32 v98, v99, v4
  v_and_b32 v99, v99, v5
  v_and_b32 v100, v101, v4
  v_and_b32 v101, v101, v5
  v_and_b32 v102, v103, v4
  v_and_b32 v103, v103, v5
  v_add_f32 v10, v10, v80
  v_add_f32 v10, v10, v81
  v_add_f32 v10, v10, v82
  v_add_f32 v10, v10, v83
  v_mfma_f32_16x16x16_bf16 v[40:43], v[96:97], v[208:209], v[40:43]
  v_mfma_f32_16x16x16_bf16 v[44:47], v[96:97], v[210:211], v[44:47]
  s_bitcmp1_b32 s33, 4
  s_cbranch_scc1 L_t117
  s_bitcmp0_b32 s33, 12
  s_cbranch_scc1 L_u117
  s_waitcnt vmcnt(3)
L_u117:
  s_waitcnt vmcnt(4)
L_t117:
  s_waitcnt vmcnt(6)
  s_xor_b32 s44, s44, 0x200000
  buffer_load_dwordx4 v[208:211], v36, s[36:39], s44 offen offset:0 nt
  v_mfma_f32_16x16x16_bf16 v[40:43], v[98:99], v[212:213], v[40:43]
  v_mfma_f32_16x16x16_bf16 v[44:47], v[98:99], v[214:215], v[44:47]
  s_bitcmp1_b32 s33, 5
  s_cbranch_scc1 L_t118
  s_bitcmp0_b32 s33, 13
  s_cbranch_scc1 L_u118
  s_waitcnt vmcnt(3)
L_u118:
  s_waitcnt vmcnt(4)
L_t118:
  s_waitcnt vmcnt(6)
  buffer_load_dwordx4 v[212:215], v36, s[36:39], s44 offen offset:1024 nt
  v_mfma_f32_16x16x16_bf16 v[40:43], v[100:101], v[216:217], v[40:43]
  v_mfma_f32_16x16x16_bf16 v[44:47], v[100:101], v[218:219], v[44:47]
  s_bitcmp1_b32 s33, 6
  s_cbranch_scc1 L_t119
  s_bitcmp0_b32 s33, 14
  s_cbranch_scc1 L_u119
  s_waitcnt vmcnt(3)
L_u119:
  s_waitcnt vmcnt(4)
L_t119:
  s_waitcnt vmcnt(6)
  buffer_load_dwordx4 v[216:219], v36, s[36:39], s44 offen offset:2048 nt
  v_mfma_f32_16x16x16_bf16 v[40:43], v[102:103], v[220:221], v[40:43]
  v_mfma_f32_16x16x16_bf16 v[44:47], v[102:103], v[222:223], v[44:47]
  s_bitcmp1_b32 s33, 7
  s_cbranch_scc1 L_t120
  s_bitcmp0_b32 s33, 15
  s_cbranch_scc1 L_u120
  s_waitcnt vmcnt(3)
L_u120:
  s_waitcnt vmcnt(4)
L_t120:
  s_waitcnt vmcnt(6)
  buffer_load_dwordx4 v[220:223], v36, s[36:39], s44 offen offset:3072 nt
  s_sub_u32 s44, s44, s45
  s_and_b32 s44, s44, s45
  s_waitcnt lgkmcnt(0)
  v_readfirstlane_b32 s33, v90
  v_readfirstlane_b32 s50, v91
  ds_read_b32 v90, v14 offset:12
  ds_add_rtn_u32 v91, v14, v15 offset:8
  s_sub_i32 s50, s50, s34
  s_addk_i32 s34, 256
  s_cmp_lt_i32 s50, 64
  s_cselect_b32 s51, 0x700, 0
  s_or_b32 s33, s33, s51
  s_cmp_ge_i32 s50, 192
  s_cselect_b32 s51, 0x7, 0
  s_or_b32 s33, s33, s51
  ds_read_b128 v[80:83], v1 offset:448
  v_fma_f32 v76, v76, s48, -v9
  v_fma_f32 v77, v77, s48, -v9
  v_fma_f32 v78, v78, s48, -v9
  v_fma_f32 v79, v79, s48, -v9
  v_exp_f32 v76, v76
  v_exp_f32 v77, v77
  v_exp_f32 v78, v78
  v_exp_f32 v79, v79
  v_cvt_pk_bf16_f32 v97, v76, v76
  v_cvt_pk_bf16_f32 v99, v77, v77
  v_cvt_pk_bf16_f32 v101, v78, v78
  v_cvt_pk_bf16_f32 v103, v79, v79
  v_and_b32 v96, v97, v4
  v_and_b32 v97, v97, v5
  v_and_b32 v98, v99, v4
  v_and_b32 v99, v99, v5
  v_and_b32 v100, v101, v4
  v_and_b32 v101, v101, v5
  v_and_b32 v102, v103, v4
  v_and_b32 v103, v103, v5
  v_add_f32 v10, v10, v76
  v_add_f32 v10, v10, v77
  v_add_f32 v10, v10, v78
  v_add_f32 v10, v10, v79
  v_mfma_f32_16x16x16_bf16 v[40:43], v[96:97], v[224:225], v[40:43]
  v_mfma_f32_16x16x16_bf16 v[44:47], v[96:97], v[226:227], v[44:47]
  s_bitcmp1_b32 s33, 0
  s_cbranch_scc1 L_t121
  s_bitcmp0_b32 s33, 8
  s_cbranch_scc1 L_u121
  s_waitcnt vmcnt(3)
L_u121:
  s_waitcnt vmcnt(4)
L_t121:
  s_waitcnt vmcnt(6)
  buffer_load_dwordx4 v[224:227], v36, s[36:39], s44 offen offset:0 nt
  v_mfma_f32_16x16x16_bf16 v[40:43], v[98:99], v[228:229], v[40:43]
  v_mfma_f32_16x16x16_bf16 v[44:47], v[98:99], v[230:231], v[44:47]
  s_bitcmp1_b32 s33, 1
  s_cbranch_scc1 L_t122
  s_bitcmp0_b32 s33, 9
  s_cbranch_scc1 L_u122
  s_waitcnt vmcnt(3)
L_u122:
  s_waitcnt vmcnt(4)
L_t122:
  s_waitcnt vmcnt(6)
  buffer_load_dwordx4 v[228:231], v36, s[36:39], s44 offen offset:1024 nt
  v_mfma_f32_16x16x16_bf16 v[40:43], v[100:101], v[232:233], v[40:43]
  v_mfma_f32_16x16x16_bf16 v[44:47], v[100:101], v[234:235], v[44:47]
  s_bitcmp1_b32 s33, 2
  s_cbranch_scc1 L_t123
  s_bitcmp0_b32 s33, 10
  s_cbranch_scc1 L_u123
  s_waitcnt vmcnt(3)
L_u123:
  s_waitcnt vmcnt(4)
L_t123:
  s_waitcnt vmcnt(6)
  buffer_load_dwordx4 v[232:235], v36, s[36:39], s44 offen offset:2048 nt
  v_mfma_f32_16x16x16_bf16 v[40:43], v[102:103], v[236:237], v[40:43]
  v_mfma_f32_16x16x16_bf16 v[44:47], v[102:103], v[238:239], v[44:47]
  s_bitcmp1_b32 s33, 3
  s_cbranch_scc1 L_t124
  s_bitcmp0_b32 s33, 11
  s_cbranch_scc1 L_u124
  s_waitcnt vmcnt(3)
L_u124:
  s_waitcnt vmcnt(4)
L_t124:
  s_waitcnt vmcnt(6)
  buffer_load_dwordx4 v[236:239], v36, s[36:39], s44 offen offset:3072 nt
  s_waitcnt lgkmcnt(0)
  ds_read_b128 v[76:79], v1 offset:512
  v_fma_f32 v80, v80, s48, -v9
  v_fma_f32 v81, v81, s48, -v9
  v_fma_f32 v82, v82, s48, -v9
  v_fma_f32 v83, v83, s48, -v9
  v_exp_f32 v80, v80
  v_exp_f32 v81, v81
  v_exp_f32 v82, v82
  v_exp_f32 v83, v83
  v_cvt_pk_bf16_f32 v97, v80, v80
  v_cvt_pk_bf16_f32 v99, v81, v81
  v_cvt_pk_bf16_f32 v101, v82, v82
  v_cvt_pk_bf16_f32 v103, v83, v83
  v_and_b32 v96, v97, v4
  v_and_b32 v97, v97, v5
  v_and_b32 v98, v99, v4
  v_and_b32 v99, v99, v5
  v_and_b32 v100, v101, v4
  v_and_b32 v101, v101, v5
  v_and_b32 v102, v103, v4
  v_and_b32 v103, v103, v5
  v_add_f32 v10, v10, v80
  v_add_f32 v10, v10, v81
  v_add_f32 v10, v10, v82
  v_add_f32 v10, v10, v83
  v_mfma_f32_16x16x16_bf16 v[40:43], v[96:97], v[240:241], v[40:43]
  v_mfma_f32_16x16x16_bf16 v[44:47], v[96:97], v[242:243], v[44:47]
  s_bitcmp1_b32 s33, 4
  s_cbranch_scc1 L_t125
  s_bitcmp0_b32 s33, 12
  s_cbranch_scc1 L_u125
  s_waitcnt vmcnt(3)
L_u125:
  s_waitcnt vmcnt(4)
L_t125:
  s_waitcnt vmcnt(6)
  s_xor_b32 s44, s44, 0x200000
  buffer_load_dwordx4 v[240:243], v36, s[36:39], s44 offen offset:0 nt
  v_mfma_f32_16x16x16_bf16 v[40:43], v[98:99], v[244:245], v[40:43]
  v_mfma_f32_16x16x16_bf16 v[44:47], v[98:99], v[246:247], v[44:47]
  s_bitcmp1_b32 s33, 5
  s_cbranch_scc1 L_t126
  s_bitcmp0_b32 s33, 13
  s_cbranch_scc1 L_u126
  s_waitcnt vmcnt(3)
L_u126:
  s_waitcnt vmcnt(4)
L_t126:
  s_waitcnt vmcnt(6)
  buffer_load_dwordx4 v[244:247], v36, s[36:39], s44 offen offset:1024 nt
  v_mfma_f32_16x16x16_bf16 v[40:43], v[100:101], v[248:249], v[40:43]
  v_mfma_f32_16x16x16_bf16 v[44:47], v[100:101], v[250:251], v[44:47]
  s_bitcmp1_b32 s33, 6
  s_cbranch_scc1 L_t127
  s_bitcmp0_b32 s33, 14
  s_cbranch_scc1 L_u127
  s_waitcnt vmcnt(3)
L_u127:
  s_waitcnt vmcnt(4)
L_t127:
  s_waitcnt vmcnt(6)
  buffer_load_dwordx4 v[248:251], v36, s[36:39], s44 offen offset:2048 nt
  v_mfma_f32_16x16x16_bf16 v[40:43], v[102:103], v[252:253], v[40:43]
  v_mfma_f32_16x16x16_bf16 v[44:47], v[102:103], v[254:255], v[44:47]
  s_bitcmp1_b32 s33, 7
  s_cbranch_scc1 L_t128
  s_bitcmp0_b32 s33, 15
  s_cbranch_scc1 L_u128
  s_waitcnt vmcnt(3)
L_u128:
  s_waitcnt vmcnt(4)
L_t128:
  s_waitcnt vmcnt(6)
  buffer_load_dwordx4 v[252:255], v36, s[36:39], s44 offen offset:3072 nt
  s_sub_u32 s44, s44, s45
  s_and_b32 s44, s44, s45
  v_add_u32 v1, 512, v1
  s_sub_u32 s47, s47, 1
  s_cmp_lg_u32 s47, 0
  s_cbranch_scc1 L_vm
  s_waitcnt lgkmcnt(0)
  v_readfirstlane_b32 s33, v90
  v_readfirstlane_b32 s50, v91
  ds_read_b32 v90, v14 offset:12
  ds_add_rtn_u32 v91, v14, v15 offset:8
  s_sub_i32 s50, s50, s34
  s_addk_i32 s34, 256
  s_cmp_lt_i32 s50, 64
  s_cselect_b32 s51, 0x700, 0
  s_or_b32 s33, s33, s51
  s_cmp_ge_i32 s50, 192
  s_cselect_b32 s51, 0x7, 0
  s_or_b32 s33, s33, s51
  ds_read_b128 v[80:83], v1 offset:64
  v_fma_f32 v76, v76, s48, -v9
  v_fma_f32 v77, v77, s48, -v9
  v_fma_f32 v78, v78, s48, -v9
  v_fma_f32 v79, v79, s48, -v9
  v_exp_f32 v76, v76
  v_exp_f32 v77, v77
  v_exp_f32 v78, v78
  v_exp_f32 v79, v79
  v_cvt_pk_bf16_f32 v97, v76, v76
  v_cvt_pk_bf16_f32 v99, v77, v77
  v_cvt_pk_bf16_f32 v101, v78, v78
  v_cvt_pk_bf16_f32 v103, v79, v79
  v_and_b32 v96, v97, v4
  v_and_b32 v97, v97, v5
  v_and_b32 v98, v99, v4
  v_and_b32 v99, v99, v5
  v_and_b32 v100, v101, v4
  v_and_b32 v101, v101, v5
  v_and_b32 v102, v103, v4
  v_and_b32 v103, v103, v5
  v_add_f32 v10, v10, v76
  v_add_f32 v10, v10, v77
  v_add_f32 v10, v10, v78
  v_add_f32 v10, v10, v79
  v_mfma_f32_16x16x16_bf16 v[40:43], v[96:97], v[128:129], v[40:43]
  v_mfma_f32_16x16x16_bf16 v[44:47], v[96:97], v[130:131], v[44:47]
  v_mfma_f32_16x16x16_bf16 v[40:43], v[98:99], v[132:133], v[40:43]
  v_mfma_f32_16x16x16_bf16 v[44:47], v[98:99], v[134:135], v[44:47]
  v_mfma_f32_16x16x16_bf16 v[40:43], v[100:101], v[136:137], v[40:43]
  v_mfma_f32_16x16x16_bf16 v[44:47], v[100:101], v[138:139], v[44:47]
  v_mfma_f32_16x16x16_bf16 v[40:43], v[102:103], v[140:141], v[40:43]
  v_mfma_f32_16x16x16_bf16 v[44:47], v[102:103], v[142:143], v[44:47]
  s_bitcmp1_b32 s33, 0
  s_cbranch_scc1 L_t129
  s_bitcmp0_b32 s33, 8
  s_cbranch_scc1 L_u129
  s_waitcnt vmcnt(3)
L_u129:
  s_waitcnt vmcnt(4)
L_t129:
  s_waitcnt vmcnt(6)
  buffer_load_dwordx4 v[128:131], v36, s[36:39], s44 offen offset:0 nt
  s_waitcnt lgkmcnt(0)
  ds_read_b128 v[76:79], v1 offset:128
  v_fma_f32 v80, v80, s48, -v9
  v_fma_f32 v81, v81, s48, -v9
  v_fma_f32 v82, v82, s48, -v9
  v_fma_f32 v83, v83, s48, -v9
  v_exp_f32 v80, v80
  v_exp_f32 v81, v81
  v_exp_f32 v82, v82
  v_exp_f32 v83, v83
  v_cvt_pk_bf16_f32 v97, v80, v80
  v_cvt_pk_bf16_f32 v99, v81, v81
  v_cvt_pk_bf16_f32 v101, v82, v82
  v_cvt_pk_bf16_f32 v103, v83, v83
  v_and_b32 v96, v97, v4
  v_and_b32 v97, v97, v5
  v_and_b32 v98, v99, v4
  v_and_b32 v99, v99, v5
  v_and_b32 v100, v101, v4
  v_and_b32 v101, v101, v5
  v_and_b32 v102, v103, v4
  v_and_b32 v103, v103, v5
  v_add_f32 v10, v10, v80
  v_add_f32 v10, v10, v81
  v_add_f32 v10, v10, v82
  v_add_f32 v10, v10, v83
  s_bitcmp1_b32 s33, 1
  s_cbranch_scc1 L_t130
  s_bitcmp0_b32 s33, 9
  s_cbranch_scc1 L_u130
  s_waitcnt vmcnt(3)
L_u130:
  s_waitcnt vmcnt(4)
L_t130:
  s_waitcnt vmcnt(6)
  buffer_load_dwordx4 v[132:135], v36, s[36:39], s44 offen offset:1024 nt
  v_mfma_f32_16x16x16_bf16 v[40:43], v[96:97], v[144:145], v[40:43]
  v_mfma_f32_16x16x16_bf16 v[44:47], v[96:97], v[146:147], v[44:47]
  v_mfma_f32_16x16x16_bf16 v[40:43], v[98:99], v[148:149], v[40:43]
  v_mfma_f32_16x16x16_bf16 v[44:47], v[98:99], v[150:151], v[44:47]
  v_mfma_f32_16x16x16_bf16 v[40:43], v[100:101], v[152:153], v[40:43]
  v_mfma_f32_16x16x16_bf16 v[44:47], v[100:101], v[154:155], v[44:47]
  v_mfma_f32_16x16x16_bf16 v[40:43], v[102:103], v[156:157], v[40:43]
  v_mfma_f32_16x16x16_bf16 v[44:47], v[102:103], v[158:159], v[44:47]
  s_bitcmp1_b32 s33, 2
  s_cbranch_scc1 L_t131
  s_bitcmp0_b32 s33, 10
  s_cbranch_scc1 L_u131
  s_waitcnt vmcnt(3)
L_u131:
  s_waitcnt vmcnt(4)
L_t131:
  s_waitcnt vmcnt(6)
  buffer_load_dwordx4 v[136:139], v36, s[36:39], s44 offen offset:2048 nt
  s_waitcnt lgkmcnt(0)
  ds_read_b128 v[80:83], v1 offset:192
  v_fma_f32 v76, v76, s48, -v9
  v_fma_f32 v77, v77, s48, -v9
  v_fma_f32 v78, v78, s48, -v9
  v_fma_f32 v79, v79, s48, -v9
  v_exp_f32 v76, v76
  v_exp_f32 v77, v77
  v_exp_f32 v78, v78
  v_exp_f32 v79, v79
  v_cvt_pk_bf16_f32 v97, v76, v76
  v_cvt_pk_bf16_f32 v99, v77, v77
  v_cvt_pk_bf16_f32 v101, v78, v78
  v_cvt_pk_bf16_f32 v103, v79, v79
  v_and_b32 v96, v97, v4
  v_and_b32 v97, v97, v5
  v_and_b32 v98, v99, v4
  v_and_b32 v99, v99, v5
  v_and_b32 v100, v101, v4
  v_and_b32 v101, v101, v5
  v_and_b32 v102, v103, v4
  v_and_b32 v103, v103, v5
  v_add_f32 v10, v10, v76
  v_add_f32 v10, v10, v77
  v_add_f32 v10, v10, v78
  v_add_f32 v10, v10, v79
  s_bitcmp1_b32 s33, 3
  s_cbranch_scc1 L_t132
  s_bitcmp0_b32 s33, 11
  s_cbranch_scc1 L_u132
  s_waitcnt vmcnt(3)
L_u132:
  s_waitcnt vmcnt(4)
L_t132:
  s_waitcnt vmcnt(6)
  buffer_load_dwordx4 v[140:143], v36, s[36:39], s44 offen offset:3072 nt
  v_mfma_f32_16x16x16_bf16 v[40:43], v[96:97], v[160:161], v[40:43]
  v_mfma_f32_16x16x16_bf16 v[44:47], v[96:97], v[162:163], v[44:47]
  v_mfma_f32_16x16x16_bf16 v[40:43], v[98:99], v[164:165], v[40:43]
  v_mfma_f32_16x16x16_bf16 v[44:47], v[98:99], v[166:167], v[44:47]
  v_mfma_f32_16x16x16_bf16 v[40:43], v[100:101], v[168:169], v[40:43]
  v_mfma_f32_16x16x16_bf16 v[44:47], v[100:101], v[170:171], v[44:47]
  v_mfma_f32_16x16x16_bf16 v[40:43], v[102:103], v[172:173], v[40:43]
  v_mfma_f32_16x16x16_bf16 v[44:47], v[102:103], v[174:175], v[44:47]
  s_bitcmp1_b32 s33, 4
  s_cbranch_scc1 L_t133
  s_bitcmp0_b32 s33, 12
  s_cbranch_scc1 L_u133
  s_waitcnt vmcnt(3)
L_u133:
  s_waitcnt vmcnt(4)
L_t133:
  s_waitcnt vmcnt(6)
  s_xor_b32 s44, s44, 0x200000
  buffer_load_dwordx4 v[144:147], v36, s[36:39], s44 offen offset:0 nt
  s_waitcnt lgkmcnt(0)
  ds_read_b128 v[76:79], v1 offset:256
  v_fma_f32 v80, v80, s48, -v9
  v_fma_f32 v81, v81, s48, -v9
  v_fma_f32 v82, v82, s48, -v9
  v_fma_f32 v83, v83, s48, -v9
  v_exp_f32 v80, v80
  v_exp_f32 v81, v81
  v_exp_f32 v82, v82
  v_exp_f32 v83, v83
  v_cvt_pk_bf16_f32 v97, v80, v80
  v_cvt_pk_bf16_f32 v99, v81, v81
  v_cvt_pk_bf16_f32 v101, v82, v82
  v_cvt_pk_bf16_f32 v103, v83, v83
  v_and_b32 v96, v97, v4
  v_and_b32 v97, v97, v5
  v_and_b32 v98, v99, v4
  v_and_b32 v99, v99, v5
  v_and_b32 v100, v101, v4
  v_and_b32 v101, v101, v5
  v_and_b32 v102, v103, v4
  v_and_b32 v103, v103, v5
  v_add_f32 v10, v10, v80
  v_add_f32 v10, v10, v81
  v_add_f32 v10, v10, v82
  v_add_f32 v10, v10, v83
  s_bitcmp1_b32 s33, 5
  s_cbranch_scc1 L_t134
  s_bitcmp0_b32 s33, 13
  s_cbranch_scc1 L_u134
  s_waitcnt vmcnt(3)
L_u134:
  s_waitcnt vmcnt(4)
L_t134:
  s_waitcnt vmcnt(6)
  buffer_load_dwordx4 v[148:151], v36, s[36:39], s44 offen offset:1024 nt
  v_mfma_f32_16x16x16_bf16 v[40:43], v[96:97], v[176:177], v[40:43]
  v_mfma_f32_16x16x16_bf16 v[44:47], v[96:97], v[178:179], v[44:47]
  v_mfma_f32_16x16x16_bf16 v[40:43], v[98:99], v[180:181], v[40:43]
  v_mfma_f32_16x16x16_bf16 v[44:47], v[98:99], v[182:183], v[44:47]
  v_mfma_f32_16x16x16_bf16 v[40:43], v[100:101], v[184:185], v[40:43]
  v_mfma_f32_16x16x16_bf16 v[44:47], v[100:101], v[186:187], v[44:47]
  v_mfma_f32_16x16x16_bf16 v[40:43], v[102:103], v[188:189], v[40:43]
  v_mfma_f32_16x16x16_bf16 v[44:47], v[102:103], v[190:191], v[44:47]
  s_bitcmp1_b32 s33, 6
  s_cbranch_scc1 L_t135
  s_bitcmp0_b32 s33, 14
  s_cbranch_scc1 L_u135
  s_waitcnt vmcnt(3)
L_u135:
  s_waitcnt vmcnt(4)
L_t135:
  s_waitcnt vmcnt(6)
  buffer_load_dwordx4 v[152:155], v36, s[36:39], s44 offen offset:2048 nt
  s_waitcnt lgkmcnt(0)
  v_readfirstlane_b32 s33, v90
  v_readfirstlane_b32 s50, v91
  ds_read_b32 v90, v14 offset:12
  ds_add_rtn_u32 v91, v14, v15 offset:8
  s_sub_i32 s50, s50, s34
  s_addk_i32 s34, 256
  s_cmp_lt_i32 s50, 64
  s_cselect_b32 s51, 0x700, 0
  s_or_b32 s33, s33, s51
  s_cmp_ge_i32 s50, 192
  s_cselect_b32 s51, 0x7, 0
  s_or_b32 s33, s33, s51
  ds_read_b128 v[80:83], v1 offset:320
  v_fma_f32 v76, v76, s48, -v9
  v_fma_f32 v77, v77, s48, -v9
  v_fma_f32 v78, v78, s48, -v9
  v_fma_f32 v79, v79, s48, -v9
  v_exp_f32 v76, v76
  v_exp_f32 v77, v77
  v_exp_f32 v78, v78
  v_exp_f32 v79, v79
  v_cvt_pk_bf16_f32 v97, v76, v76
  v_cvt_pk_bf16_f32 v99, v77, v77
  v_cvt_pk_bf16_f32 v101, v78, v78
  v_cvt_pk_bf16_f32 v103, v79, v79
  v_and_b32 v96, v97, v4
  v_and_b32 v97, v97, v5
  v_and_b32 v98, v99, v4
  v_and_b32 v99, v99, v5
  v_and_b32 v100, v101, v4
  v_and_b32 v101, v101, v5
  v_and_b32 v102, v103, v4
  v_and_b32 v103, v103, v5
  v_add_f32 v10, v10, v76
  v_add_f32 v10, v10, v77
  v_add_f32 v10, v10, v78
  v_add_f32 v10, v10, v79
  s_bitcmp1_b32 s33, 7
  s_cbranch_scc1 L_t136
  s_bitcmp0_b32 s33, 15
  s_cbranch_scc1 L_u136
  s_waitcnt vmcnt(3)
L_u136:
  s_waitcnt vmcnt(4)
L_t136:
  s_waitcnt vmcnt(6)
  buffer_load_dwordx4 v[156:159], v36, s[36:39], s44 offen offset:3072 nt
  s_sub_u32 s44, s44, s45
  s_and_b32 s44, s44, s45
  v_mfma_f32_16x16x16_bf16 v[40:43], v[96:97], v[192:193], v[40:43]
  v_mfma_f32_16x16x16_bf16 v[44:47], v[96:97], v[194:195], v[44:47]
  v_mfma_f32_16x16x16_bf16 v[40:43], v[98:99], v[196:197], v[40:43]
  v_mfma_f32_16x16x16_bf16 v[44:47], v[98:99], v[198:199], v[44:47]
  v_mfma_f32_16x16x16_bf16 v[40:43], v[100:101], v[200:201], v[40:43]
  v_mfma_f32_16x16x16_bf16 v[44:47], v[100:101], v[202:203], v[44:47]
  v_mfma_f32_16x16x16_bf16 v[40:43], v[102:103], v[204:205], v[40:43]
  v_mfma_f32_16x16x16_bf16 v[44:47], v[102:103], v[206:207], v[44:47]
  s_bitcmp1_b32 s33, 0
  s_cbranch_scc1 L_t137
  s_bitcmp0_b32 s33, 8
  s_cbranch_scc1 L_u137
  s_waitcnt vmcnt(3)
L_u137:
  s_waitcnt vmcnt(4)
L_t137:
  s_waitcnt vmcnt(6)
  buffer_load_dwordx4 v[160:163], v36, s[36:39], s44 offen offset:0 nt
  s_waitcnt lgkmcnt(0)
  ds_read_b128 v[76:79], v1 offset:384
  v_fma_f32 v80, v80, s48, -v9
  v_fma_f32 v81, v81, s48, -v9
  v_fma_f32 v82, v82, s48, -v9
  v_fma_f32 v83, v83, s48, -v9
  v_exp_f32 v80, v80
  v_exp_f32 v81, v81
  v_exp_f32 v82, v82
  v_exp_f32 v83, v83
  v_cvt_pk_bf16_f32 v97, v80, v80
  v_cvt_pk_bf16_f32 v99, v81, v81
  v_cvt_pk_bf16_f32 v101, v82, v82
  v_cvt_pk_bf16_f32 v103, v83, v83
  v_and_b32 v96, v97, v4
  v_and_b32 v97, v97, v5
  v_and_b32 v98, v99, v4
  v_and_b32 v99, v99, v5
  v_and_b32 v100, v101, v4
  v_and_b32 v101, v101, v5
  v_and_b32 v102, v103, v4
  v_and_b32 v103, v103, v5
  v_add_f32 v10, v10, v80
  v_add_f32 v10, v10, v81
  v_add_f32 v10, v10, v82
  v_add_f32 v10, v10, v83
  s_bitcmp1_b32 s33, 1
  s_cbranch_scc1 L_t138
  s_bitcmp0_b32 s33, 9
  s_cbranch_scc1 L_u138
  s_waitcnt vmcnt(3)
L_u138:
  s_waitcnt vmcnt(4)
L_t138:
  s_waitcnt vmcnt(6)
  buffer_load_dwordx4 v[164:167], v36, s[36:39], s44 offen offset:1024 nt
  v_mfma_f32_16x16x16_bf16 v[40:43], v[96:97], v[208:209], v[40:43]
  v_mfma_f32_16x16x16_bf16 v[44:47], v[96:97], v[210:211], v[44:47]
  v_mfma_f32_16x16x16_bf16 v[40:43], v[98:99], v[212:213], v[40:43]
  v_mfma_f32_16x16x16_bf16 v[44:47], v[98:99], v[214:215], v[44:47]
  v_mfma_f32_16x16x16_bf16 v[40:43], v[100:101], v[216:217], v[40:43]
  v_mfma_f32_16x16x16_bf16 v[44:47], v[100:101], v[218:219], v[44:47]
  v_mfma_f32_16x16x16_bf16 v[40:43], v[102:103], v[220:221], v[40:43]
  v_mfma_f32_16x16x16_bf16 v[44:47], v[102:103], v[222:223], v[44:47]
  s_bitcmp1_b32 s33, 2
  s_cbranch_scc1 L_t139
  s_bitcmp0_b32 s33, 10
  s_cbranch_scc1 L_u139
  s_waitcnt vmcnt(3)
L_u139:
  s_waitcnt vmcnt(4)
L_t139:
  s_waitcnt vmcnt(6)
  buffer_load_dwordx4 v[168:171], v36, s[36:39], s44 offen offset:2048 nt
  s_waitcnt lgkmcnt(0)
  ds_read_b128 v[80:83], v1 offset:448
  v_fma_f32 v76, v76, s48, -v9
  v_fma_f32 v77, v77, s48, -v9
  v_fma_f32 v78, v78, s48, -v9
  v_fma_f32 v79, v79, s48, -v9
  v_exp_f32 v76, v76
  v_exp_f32 v77, v77
  v_exp_f32 v78, v78
  v_exp_f32 v79, v79
  v_cvt_pk_bf16_f32 v97, v76, v76
  v_cvt_pk_bf16_f32 v99, v77, v77
  v_cvt_pk_bf16_f32 v101, v78, v78
  v_cvt_pk_bf16_f32 v103, v79, v79
  v_and_b32 v96, v97, v4
  v_and_b32 v97, v97, v5
  v_and_b32 v98, v99, v4
  v_and_b32 v99, v99, v5
  v_and_b32 v100, v101, v4
  v_and_b32 v101, v101, v5
  v_and_b32 v102, v103, v4
  v_and_b32 v103, v103, v5
  v_add_f32 v10, v10, v76
  v_add_f32 v10, v10, v77
  v_add_f32 v10, v10, v78
  v_add_f32 v10, v10, v79
  s_bitcmp1_b32 s33, 3
  s_cbranch_scc1 L_t140
  s_bitcmp0_b32 s33, 11
  s_cbranch_scc1 L_u140
  s_waitcnt vmcnt(3)
L_u140:
  s_waitcnt vmcnt(4)
L_t140:
  s_waitcnt vmcnt(6)
  buffer_load_dwordx4 v[172:175], v36, s[36:39], s44 offen offset:3072 nt
  v_mfma_f32_16x16x16_bf16 v[40:43], v[96:97], v[224:225], v[40:43]
  v_mfma_f32_16x16x16_bf16 v[44:47], v[96:97], v[226:227], v[44:47]
  v_mfma_f32_16x16x16_bf16 v[40:43], v[98:99], v[228:229], v[40:43]
  v_mfma_f32_16x16x16_bf16 v[44:47], v[98:99], v[230:231], v[44:47]
  v_mfma_f32_16x16x16_bf16 v[40:43], v[100:101], v[232:233], v[40:43]
  v_mfma_f32_16x16x16_bf16 v[44:47], v[100:101], v[234:235], v[44:47]
  v_mfma_f32_16x16x16_bf16 v[40:43], v[102:103], v[236:237], v[40:43]
  v_mfma_f32_16x16x16_bf16 v[44:47], v[102:103], v[238:239], v[44:47]
  s_bitcmp1_b32 s33, 4
  s_cbranch_scc1 L_t141
  s_bitcmp0_b32 s33, 12
  s_cbranch_scc1 L_u141
  s_waitcnt vmcnt(3)
L_u141:
  s_waitcnt vmcnt(4)
L_t141:
  s_waitcnt vmcnt(6)
  s_xor_b32 s44, s44, 0x200000
  buffer_load_dwordx4 v[176:179], v36, s[36:39], s44 offen offset:0 nt
  s_waitcnt lgkmcnt(0)
  ds_read_b128 v[76:79], v1 offset:512
  v_fma_f32 v80, v80, s48, -v9
  v_fma_f32 v81, v81, s48, -v9
  v_fma_f32 v82, v82, s48, -v9
  v_fma_f32 v83, v83, s48, -v9
  v_exp_f32 v80, v80
  v_exp_f32 v81, v81
  v_exp_f32 v82, v82
  v_exp_f32 v83, v83
  v_cvt_pk_bf16_f32 v97, v80, v80
  v_cvt_pk_bf16_f32 v99, v81, v81
  v_cvt_pk_bf16_f32 v101, v82, v82
  v_cvt_pk_bf16_f32 v103, v83, v83
  v_and_b32 v96, v97, v4
  v_and_b32 v97, v97, v5
  v_and_b32 v98, v99, v4
  v_and_b32 v99, v99, v5
  v_and_b32 v100, v101, v4
  v_and_b32 v101, v101, v5
  v_and_b32 v102, v103, v4
  v_and_b32 v103, v103, v5
  v_add_f32 v10, v10, v80
  v_add_f32 v10, v10, v81
  v_add_f32 v10, v10, v82
  v_add_f32 v10, v10, v83
  s_bitcmp1_b32 s33, 5
  s_cbranch_scc1 L_t142
  s_bitcmp0_b32 s33, 13
  s_cbranch_scc1 L_u142
  s_waitcnt vmcnt(3)
L_u142:
  s_waitcnt vmcnt(4)
L_t142:
  s_waitcnt vmcnt(6)
  buffer_load_dwordx4 v[180:183], v36, s[36:39], s44 offen offset:1024 nt
  v_mfma_f32_16x16x16_bf16 v[40:43], v[96:97], v[240:241], v[40:43]
  v_mfma_f32_16x16x16_bf16 v[44:47], v[96:97], v[242:243], v[44:47]
  v_mfma_f32_16x16x16_bf16 v[40:43], v[98:99], v[244:245], v[40:43]
  v_mfma_f32_16x16x16_bf16 v[44:47], v[98:99], v[246:247], v[44:47]
  v_mfma_f32_16x16x16_bf16 v[40:43], v[100:101], v[248:249], v[40:43]
  v_mfma_f32_16x16x16_bf16 v[44:47], v[100:101], v[250:251], v[44:47]
  v_mfma_f32_16x16x16_bf16 v[40:43], v[102:103], v[252:253], v[40:43]
  v_mfma_f32_16x16x16_bf16 v[44:47], v[102:103], v[254:255], v[44:47]
  s_bitcmp1_b32 s33, 6
  s_cbranch_scc1 L_t143
  s_bitcmp0_b32 s33, 14
  s_cbranch_scc1 L_u143
  s_waitcnt vmcnt(3)
L_u143:
  s_waitcnt vmcnt(4)
L_t143:
  s_waitcnt vmcnt(6)
  buffer_load_dwordx4 v[184:187], v36, s[36:39], s44 offen offset:2048 nt
  s_waitcnt lgkmcnt(0)
  ds_read_b128 v[80:83], v1 offset:576
  v_fma_f32 v76, v76, s48, -v9
  v_fma_f32 v77, v77, s48, -v9
  v_fma_f32 v78, v78, s48, -v9
  v_fma_f32 v79, v79, s48, -v9
  v_exp_f32 v76, v76
  v_exp_f32 v77, v77
  v_exp_f32 v78, v78
  v_exp_f32 v79, v79
  v_cvt_pk_bf16_f32 v97, v76, v76
  v_cvt_pk_bf16_f32 v99, v77, v77
  v_cvt_pk_bf16_f32 v101, v78, v78
  v_cvt_pk_bf16_f32 v103, v79, v79
  v_and_b32 v96, v97, v4
  v_and_b32 v97, v97, v5
  v_and_b32 v98, v99, v4
  v_and_b32 v99, v99, v5
  v_and_b32 v100, v101, v4
  v_and_b32 v101, v101, v5
  v_and_b32 v102, v103, v4
  v_and_b32 v103, v103, v5
  v_add_f32 v10, v10, v76
  v_add_f32 v10, v10, v77
  v_add_f32 v10, v10, v78
  v_add_f32 v10, v10, v79
  s_bitcmp1_b32 s33, 7
  s_cbranch_scc1 L_t144
  s_bitcmp0_b32 s33, 15
  s_cbranch_scc1 L_u144
  s_waitcnt vmcnt(3)
L_u144:
  s_waitcnt vmcnt(4)
L_t144:
  s_waitcnt vmcnt(6)
  buffer_load_dwordx4 v[188:191], v36, s[36:39], s44 offen offset:3072 nt
  s_sub_u32 s44, s44, s45
  s_and_b32 s44, s44, s45
  s_waitcnt vmcnt(12)
  v_mfma_f32_16x16x16_bf16 v[40:43], v[96:97], v[128:129], v[40:43]
  v_mfma_f32_16x16x16_bf16 v[44:47], v[96:97], v[130:131], v[44:47]
  v_mfma_f32_16x16x16_bf16 v[40:43], v[98:99], v[132:133], v[40:43]
  v_mfma_f32_16x16x16_bf16 v[44:47], v[98:99], v[134:135], v[44:47]
  v_mfma_f32_16x16x16_bf16 v[40:43], v[100:101], v[136:137], v[40:43]
  v_mfma_f32_16x16x16_bf16 v[44:47], v[100:101], v[138:139], v[44:47]
  v_mfma_f32_16x16x16_bf16 v[40:43], v[102:103], v[140:141], v[40:43]
  v_mfma_f32_16x16x16_bf16 v[44:47], v[102:103], v[142:143], v[44:47]
  s_waitcnt lgkmcnt(0)
  v_readfirstlane_b32 s33, v90
  v_readfirstlane_b32 s50, v91
  ds_read_b32 v90, v14 offset:12
  ds_add_rtn_u32 v91, v14, v15 offset:8
  s_sub_i32 s50, s50, s34
  s_addk_i32 s34, 256
  s_cmp_lt_i32 s50, 64
  s_cselect_b32 s51, 0x700, 0
  s_or_b32 s33, s33, s51
  s_cmp_ge_i32 s50, 192
  s_cselect_b32 s51, 0x7, 0
  s_or_b32 s33, s33, s51
  s_bitcmp1_b32 s33, 31
  s_cbranch_scc1 L_v145
  s_bitcmp1_b32 s33, 0
  s_cbranch_scc1 L_t145
  s_bitcmp0_b32 s33, 8
  s_cbranch_scc1 L_u145
  s_waitcnt vmcnt(3)
L_u145:
  s_waitcnt vmcnt(4)
L_t145:
  s_waitcnt vmcnt(6)
L_v145:
  buffer_load_dwordx4 v[192:195], v36, s[36:39], s44 offen offset:0 nt
  s_waitcnt lgkmcnt(0)
  ds_read_b128 v[76:79], v1 offset:640
  v_fma_f32 v80, v80, s48, -v9
  v_fma_f32 v81, v81, s48, -v9
  v_fma_f32 v82, v82, s48, -v9
  v_fma_f32 v83, v83, s48, -v9
  v_exp_f32 v80, v80
  v_exp_f32 v81, v81
  v_exp_f32 v82, v82
  v_exp_f32 v83, v83
  v_cvt_pk_bf16_f32 v97, v80, v80
  v_cvt_pk_bf16_f32 v99, v81, v81
  v_cvt_pk_bf16_f32 v101, v82, v82
  v_cvt_pk_bf16_f32 v103, v83, v83
  v_and_b32 v96, v97, v4
  v_and_b32 v97, v97, v5
  v_and_b32 v98, v99, v4
  v_and_b32 v99, v99, v5
  v_and_b32 v100, v101, v4
  v_and_b32 v101, v101, v5
  v_and_b32 v102, v103, v4
  v_and_b32 v103, v103, v5
  v_add_f32 v10, v10, v80
  v_add_f32 v10, v10, v81
  v_add_f32 v10, v10, v82
  v_add_f32 v10, v10, v83
  s_bitcmp1_b32 s33, 30
  s_cbranch_scc1 L_v146
  s_bitcmp1_b32 s33, 1
  s_cbranch_scc1 L_t146
  s_bitcmp0_b32 s33, 9
  s_cbranch_scc1 L_u146
  s_waitcnt vmcnt(3)
L_u146:
  s_waitcnt vmcnt(4)
L_t146:
  s_waitcnt vmcnt(6)
L_v146:
  buffer_load_dwordx4 v[196:199], v36, s[36:39], s44 offen offset:1024 nt
  s_waitcnt vmcnt(10)
  v_mfma_f32_16x16x16_bf16 v[40:43], v[96:97], v[144:145], v[40:43]
  v_mfma_f32_16x16x16_bf16 v[44:47], v[96:97], v[146:147], v[44:47]
  v_mfma_f32_16x16x16_bf16 v[40:43], v[98:99], v[148:149], v[40:43]
  v_mfma_f32_16x16x16_bf16 v[44:47], v[98:99], v[150:151], v[44:47]
  v_mfma_f32_16x16x16_bf16 v[40:43], v[100:101], v[152:153], v[40:43]
  v_mfma_f32_16x16x16_bf16 v[44:47], v[100:101], v[154:155], v[44:47]
  v_mfma_f32_16x16x16_bf16 v[40:43], v[102:103], v[156:157], v[40:43]
  v_mfma_f32_16x16x16_bf16 v[44:47], v[102:103], v[158:159], v[44:47]
  s_bitcmp1_b32 s33, 29
  s_cbranch_scc1 L_v147
  s_bitcmp1_b32 s33, 2
  s_cbranch_scc1 L_t147
  s_bitcmp0_b32 s33, 10
  s_cbranch_scc1 L_u147
  s_waitcnt vmcnt(3)
L_u147:
  s_waitcnt vmcnt(4)
L_t147:
  s_waitcnt vmcnt(6)
L_v147:
  buffer_load_dwordx4 v[200:203], v36, s[36:39], s44 offen offset:2048 nt
  s_waitcnt lgkmcnt(0)
  ds_read_b128 v[80:83], v1 offset:704
  v_fma_f32 v76, v76, s48, -v9
  v_fma_f32 v77, v77, s48, -v9
  v_fma_f32 v78, v78, s48, -v9
  v_fma_f32 v79, v79, s48, -v9
  v_exp_f32 v76, v76
  v_exp_f32 v77, v77
  v_exp_f32 v78, v78
  v_exp_f32 v79, v79
  v_cvt_pk_bf16_f32 v97, v76, v76
  v_cvt_pk_bf16_f32 v99, v77, v77
  v_cvt_pk_bf16_f32 v101, v78, v78
  v_cvt_pk_bf16_f32 v103, v79, v79
  v_and_b32 v96, v97, v4
  v_and_b32 v97, v97, v5
  v_and_b32 v98, v99, v4
  v_and_b32 v99, v99, v5
  v_and_b32 v100, v101, v4
  v_and_b32 v101, v101, v5
  v_and_b32 v102, v103, v4
  v_and_b32 v103, v103, v5
  v_add_f32 v10, v10, v76
  v_add_f32 v10, v10, v77
  v_add_f32 v10, v10, v78
  v_add_f32 v10, v10, v79
  s_bitcmp1_b32 s33, 28
  s_cbranch_scc1 L_v148
  s_bitcmp1_b32 s33, 3
  s_cbranch_scc1 L_t148
  s_bitcmp0_b32 s33, 11
  s_cbranch_scc1 L_u148
  s_waitcnt vmcnt(3)
L_u148:
  s_waitcnt vmcnt(4)
L_t148:
  s_waitcnt vmcnt(6)
L_v148:
  buffer_load_dwordx4 v[204:207], v36, s[36:39], s44 offen offset:3072 nt
  s_waitcnt vmcnt(8)
  v_mfma_f32_16x16x16_bf16 v[40:43], v[96:97], v[160:161], v[40:43]
  v_mfma_f32_16x16x16_bf16 v[44:47], v[96:97], v[162:163], v[44:47]
  v_mfma_f32_16x16x16_bf16 v[40:43], v[98:99], v[164:165], v[40:43]
  v_mfma_f32_16x16x16_bf16 v[44:47], v[98:99], v[166:167], v[44:47]
  v_mfma_f32_16x16x16_bf16 v[40:43], v[100:101], v[168:169], v[40:43]
  v_mfma_f32_16x16x16_bf16 v[44:47], v[100:101], v[170:171], v[44:47]
  v_mfma_f32_16x16x16_bf16 v[40:43], v[102:103], v[172:173], v[40:43]
  v_mfma_f32_16x16x16_bf16 v[44:47], v[102:103], v[174:175], v[44:47]
  s_bitcmp1_b32 s33, 27
  s_cbranch_scc1 L_v149
  s_bitcmp1_b32 s33, 4
  s_cbranch_scc1 L_t149
  s_bitcmp0_b32 s33, 12
  s_cbranch_scc1 L_u149
  s_waitcnt vmcnt(3)
L_u149:
  s_waitcnt vmcnt(4)
L_t149:
  s_waitcnt vmcnt(6)
L_v149:
  s_xor_b32 s44, s44, 0x200000
  buffer_load_dwordx4 v[208:211], v36, s[36:39], s44 offen offset:0 nt
  s_waitcnt lgkmcnt(0)
  ds_read_b128 v[76:79], v1 offset:768
  v_fma_f32 v80, v80, s48, -v9
  v_fma_f32 v81, v81, s48, -v9
  v_fma_f32 v82, v82, s48, -v9
  v_fma_f32 v83, v83, s48, -v9
  v_exp_f32 v80, v80
  v_exp_f32 v81, v81
  v_exp_f32 v82, v82
  v_exp_f32 v83, v83
  v_cvt_pk_bf16_f32 v97, v80, v80
  v_cvt_pk_bf16_f32 v99, v81, v81
  v_cvt_pk_bf16_f32 v101, v82, v82
  v_cvt_pk_bf16_f32 v103, v83, v83
  v_and_b32 v96, v97, v4
  v_and_b32 v97, v97, v5
  v_and_b32 v98, v99, v4
  v_and_b32 v99, v99, v5
  v_and_b32 v100, v101, v4
  v_and_b32 v101, v101, v5
  v_and_b32 v102, v103, v4
  v_and_b32 v103, v103, v5
  v_add_f32 v10, v10, v80
  v_add_f32 v10, v10, v81
  v_add_f32 v10, v10, v82
  v_add_f32 v10, v10, v83
  s_bitcmp1_b32 s33, 26
  s_cbranch_scc1 L_v150
  s_bitcmp1_b32 s33, 5
  s_cbranch_scc1 L_t150
  s_bitcmp0_b32 s33, 13
  s_cbranch_scc1 L_u150
  s_waitcnt vmcnt(3)
L_u150:
  s_waitcnt vmcnt(4)
L_t150:
  s_waitcnt vmcnt(6)
L_v150:
  buffer_load_dwordx4 v[212:215], v36, s[36:39], s44 offen offset:1024 nt
  s_waitcnt vmcnt(6)
  v_mfma_f32_16x16x16_bf16 v[40:43], v[96:97], v[176:177], v[40:43]
  v_mfma_f32_16x16x16_bf16 v[44:47], v[96:97], v[178:179], v[44:47]
  v_mfma_f32_16x16x16_bf16 v[40:43], v[98:99], v[180:181], v[40:43]
  v_mfma_f32_16x16x16_bf16 v[44:47], v[98:99], v[182:183], v[44:47]
  v_mfma_f32_16x16x16_bf16 v[40:43], v[100:101], v[184:185], v[40:43]
  v_mfma_f32_16x16x16_bf16 v[44:47], v[100:101], v[186:187], v[44:47]
  v_mfma_f32_16x16x16_bf16 v[40:43], v[102:103], v[188:189], v[40:43]
  v_mfma_f32_16x16x16_bf16 v[44:47], v[102:103], v[190:191], v[44:47]
  s_bitcmp1_b32 s33, 25
  s_cbranch_scc1 L_v151
  s_bitcmp1_b32 s33, 6
  s_cbranch_scc1 L_t151
  s_bitcmp0_b32 s33, 14
  s_cbranch_scc1 L_u151
  s_waitcnt vmcnt(3)
L_u151:
  s_waitcnt vmcnt(4)
L_t151:
  s_waitcnt vmcnt(6)
L_v151:
  buffer_load_dwordx4 v[216:219], v36, s[36:39], s44 offen offset:2048 nt
  s_bitcmp1_b32 s33, 24
  s_cbranch_scc1 L_v152
  s_bitcmp1_b32 s33, 7
  s_cbranch_scc1 L_t152
  s_bitcmp0_b32 s33, 15
  s_cbranch_scc1 L_u152
  s_waitcnt vmcnt(3)
L_u152:
  s_waitcnt vmcnt(4)
L_t152:
  s_waitcnt vmcnt(6)
L_v152:
  buffer_load_dwordx4 v[220:223], v36, s[36:39], s44 offen offset:3072 nt
  s_sub_u32 s44, s44, s45
  s_and_b32 s44, s44, s45
  s_waitcnt lgkmcnt(0)
  v_readfirstlane_b32 s33, v90
  v_readfirstlane_b32 s50, v91
  ds_read_b32 v90, v14 offset:12
  ds_add_rtn_u32 v91, v14, v15 offset:8
  s_sub_i32 s50, s50, s34
  s_addk_i32 s34, 256
  s_cmp_lt_i32 s50, 64
  s_cselect_b32 s51, 0x700, 0
  s_or_b32 s33, s33, s51
  s_cmp_ge_i32 s50, 192
  s_cselect_b32 s51, 0x7, 0
  s_or_b32 s33, s33, s51
  s_mul_i32 s50, s3, 576
  s_add_u32 s50, s50, 3328
  v_add_u32 v6, s50, v3
  v_lshl_add_u32 v7, v0, 2, s50
  s_lshl_b32 s50, s3, 2
  v_mov_b32 v14, s50
  ds_read_b128 v[56:59], v1 offset:832
  ds_read_b128 v[60:63], v1 offset:896
  ds_read_b128 v[64:67], v1 offset:960
  ds_write_b32 v14, v9 offset:2560
  v_fma_f32 v76, v76, s48, -v9
  v_fma_f32 v77, v77, s48, -v9
  v_fma_f32 v78, v78, s48, -v9
  v_fma_f32 v79, v79, s48, -v9
  v_exp_f32 v76, v76
  v_exp_f32 v77, v77
  v_exp_f32 v78, v78
  v_exp_f32 v79, v79
  v_cvt_pk_bf16_f32 v97, v76, v76
  v_cvt_pk_bf16_f32 v99, v77, v77
  v_cvt_pk_bf16_f32 v101, v78, v78
  v_cvt_pk_bf16_f32 v103, v79, v79
  v_and_b32 v96, v97, v4
  v_and_b32 v97, v97, v5
  v_and_b32 v98, v99, v4
  v_and_b32 v99, v99, v5
  v_and_b32 v100, v101, v4
  v_and_b32 v101, v101, v5
  v_and_b32 v102, v103, v4
  v_and_b32 v103, v103, v5
  v_add_f32 v10, v10, v76
  v_add_f32 v10, v10, v77
  v_add_f32 v10, v10, v78
  v_add_f32 v10, v10, v79
  s_bitcmp1_b32 s33, 23
  s_cbranch_scc1 L_v153
  s_bitcmp1_b32 s33, 0
  s_cbranch_scc1 L_t153
  s_bitcmp0_b32 s33, 8
  s_cbranch_scc1 L_u153
  s_waitcnt vmcnt(3)
L_u153:
  s_waitcnt vmcnt(4)
L_t153:
  s_waitcnt vmcnt(6)
L_v153:
  buffer_load_dwordx4 v[224:227], v36, s[36:39], s44 offen offset:0 nt
  s_waitcnt lgkmcnt(0)
  v_fma_f32 v56, v56, s48, -v9
  v_fma_f32 v57, v57, s48, -v9
  v_fma_f32 v58, v58, s48, -v9
  v_fma_f32 v59, v59, s48, -v9
  v_exp_f32 v56, v56
  v_exp_f32 v57, v57
  v_exp_f32 v58, v58
  v_exp_f32 v59, v59
  v_cvt_pk_bf16_f32 v105, v56, v56
  v_cvt_pk_bf16_f32 v107, v57, v57
  v_cvt_pk_bf16_f32 v109, v58, v58
  v_cvt_pk_bf16_f32 v111, v59, v59
  v_and_b32 v104, v105, v4
  v_and_b32 v105, v105, v5
  v_and_b32 v106, v107, v4
  v_and_b32 v107, v107, v5
  v_and_b32 v108, v109, v4
  v_and_b32 v109, v109, v5
  v_and_b32 v110, v111, v4
  v_and_b32 v111, v111, v5
  v_add_f32 v10, v10, v56
  v_add_f32 v10, v10, v57
  v_add_f32 v10, v10, v58
  v_add_f32 v10, v10, v59
  s_bitcmp1_b32 s33, 22
  s_cbranch_scc1 L_v154
  s_bitcmp1_b32 s33, 1
  s_cbranch_scc1 L_t154
  s_bitcmp0_b32 s33, 9
  s_cbranch_scc1 L_u154
  s_waitcnt vmcnt(3)
L_u154:
  s_waitcnt vmcnt(4)
L_t154:
  s_waitcnt vmcnt(6)
L_v154:
  buffer_load_dwordx4 v[228:231], v36, s[36:39], s44 offen offset:1024 nt
  v_fma_f32 v60, v60, s48, -v9
  v_fma_f32 v61, v61, s48, -v9
  v_fma_f32 v62, v62, s48, -v9
  v_fma_f32 v63, v63, s48, -v9
  v_exp_f32 v60, v60
  v_exp_f32 v61, v61
  v_exp_f32 v62, v62
  v_exp_f32 v63, v63
  v_cvt_pk_bf16_f32 v113, v60, v60
  v_cvt_pk_bf16_f32 v115, v61, v61
  v_cvt_pk_bf16_f32 v117, v62, v62
  v_cvt_pk_bf16_f32 v119, v63, v63
  v_and_b32 v112, v113, v4
  v_and_b32 v113, v113, v5
  v_and_b32 v114, v115, v4
  v_and_b32 v115, v115, v5
  v_and_b32 v116, v117, v4
  v_and_b32 v117, v117, v5
  v_and_b32 v118, v119, v4
  v_and_b32 v119, v119, v5
  v_add_f32 v10, v10, v60
  v_add_f32 v10, v10, v61
  v_add_f32 v10, v10, v62
  v_add_f32 v10, v10, v63
  s_bitcmp1_b32 s33, 21
  s_cbranch_scc1 L_v155
  s_bitcmp1_b32 s33, 2
  s_cbranch_scc1 L_t155
  s_bitcmp0_b32 s33, 10
  s_cbranch_scc1 L_u155
  s_waitcnt vmcnt(3)
L_u155:
  s_waitcnt vmcnt(4)
L_t155:
  s_waitcnt vmcnt(6)
L_v155:
  buffer_load_dwordx4 v[232:235], v36, s[36:39], s44 offen offset:2048 nt
  v_fma_f32 v64, v64, s48, -v9
  v_fma_f32 v65, v65, s48, -v9
  v_fma_f32 v66, v66, s48, -v9
  v_fma_f32 v67, v67, s48, -v9
  v_exp_f32 v64, v64
  v_exp_f32 v65, v65
  v_exp_f32 v66, v66
  v_exp_f32 v67, v67
  v_cvt_pk_bf16_f32 v121, v64, v64
  v_cvt_pk_bf16_f32 v123, v65, v65
  v_cvt_pk_bf16_f32 v125, v66, v66
  v_cvt_pk_bf16_f32 v127, v67, v67
  v_and_b32 v120, v121, v4
  v_and_b32 v121, v121, v5
  v_and_b32 v122, v123, v4
  v_and_b32 v123, v123, v5
  v_and_b32 v124, v125, v4
  v_and_b32 v125, v125, v5
  v_and_b32 v126, v127, v4
  v_and_b32 v127, v127, v5
  v_add_f32 v10, v10, v64
  v_add_f32 v10, v10, v65
  v_add_f32 v10, v10, v66
  v_add_f32 v10, v10, v67
  s_bitcmp1_b32 s33, 20
  s_cbranch_scc1 L_v156
  s_bitcmp1_b32 s33, 3
  s_cbranch_scc1 L_t156
  s_bitcmp0_b32 s33, 11
  s_cbranch_scc1 L_u156
  s_waitcnt vmcnt(3)
L_u156:
  s_waitcnt vmcnt(4)
L_t156:
  s_waitcnt vmcnt(6)
L_v156:
  buffer_load_dwordx4 v[236:239], v36, s[36:39], s44 offen offset:3072 nt
  ds_write_b32 v7, v10 offset:256
  s_mov_b32 s40, s24
  s_mov_b32 s41, s25
  s_mov_b32 s42, 4096
  s_xor_b32 s44, s44, 0x200000
  buffer_load_dwordx4 v[240:243], v36, s[36:39], s44 offen offset:0 nt
  s_waitcnt vmcnt(12)
  v_mfma_f32_16x16x16_bf16 v[40:43], v[96:97], v[192:193], v[40:43]
  v_mfma_f32_16x16x16_bf16 v[44:47], v[96:97], v[194:195], v[44:47]
  buffer_load_dwordx4 v[244:247], v36, s[36:39], s44 offen offset:1024 nt
  s_waitcnt vmcnt(12)
  v_mfma_f32_16x16x16_bf16 v[40:43], v[98:99], v[196:197], v[40:43]
  v_mfma_f32_16x16x16_bf16 v[44:47], v[98:99], v[198:199], v[44:47]
  buffer_load_dwordx4 v[248:251], v36, s[36:39], s44 offen offset:2048 nt
  s_waitcnt vmcnt(12)
  v_mfma_f32_16x16x16_bf16 v[40:43], v[100:101], v[200:201], v[40:43]
  v_mfma_f32_16x16x16_bf16 v[44:47], v[100:101], v[202:203], v[44:47]
  buffer_load_dwordx4 v[252:255], v36, s[36:39], s44 offen offset:3072 nt
  s_sub_u32 s44, s44, s45
  s_and_b32 s44, s44, s45
  s_add_u32 s36, s28, 0x0
  s_addc_u32 s37, s29, 0
  s_waitcnt vmcnt(12)
  v_mfma_f32_16x16x16_bf16 v[40:43], v[102:103], v[204:205], v[40:43]
  v_mfma_f32_16x16x16_bf16 v[44:47], v[102:103], v[206:207], v[44:47]
  s_waitcnt vmcnt(11)
  v_mfma_f32_16x16x16_bf16 v[40:43], v[104:105], v[208:209], v[40:43]
  v_mfma_f32_16x16x16_bf16 v[44:47], v[104:105], v[210:211], v[44:47]
  s_waitcnt vmcnt(10)
  v_mfma_f32_16x16x16_bf16 v[40:43], v[106:107], v[212:213], v[40:43]
  v_mfma_f32_16x16x16_bf16 v[44:47], v[106:107], v[214:215], v[44:47]
  s_waitcnt vmcnt(9)
  v_mfma_f32_16x16x16_bf16 v[40:43], v[108:109], v[216:217], v[40:43]
  v_mfma_f32_16x16x16_bf16 v[44:47], v[108:109], v[218:219], v[44:47]
  s_waitcnt vmcnt(8)
  v_mfma_f32_16x16x16_bf16 v[40:43], v[110:111], v[220:221], v[40:43]
  v_mfma_f32_16x16x16_bf16 v[44:47], v[110:111], v[222:223], v[44:47]
  s_waitcnt vmcnt(7)
  v_mfma_f32_16x16x16_bf16 v[40:43], v[112:113], v[224:225], v[40:43]
  v_mfma_f32_16x16x16_bf16 v[44:47], v[112:113], v[226:227], v[44:47]
  s_waitcnt vmcnt(6)
  v_mfma_f32_16x16x16_bf16 v[40:43], v[114:115], v[228:229], v[40:43]
  v_mfma_f32_16x16x16_bf16 v[44:47], v[114:115], v[230:231], v[44:47]
  s_waitcnt vmcnt(5)
  v_mfma_f32_16x16x16_bf16 v[40:43], v[116:117], v[232:233], v[40:43]
  v_mfma_f32_16x16x16_bf16 v[44:47], v[116:117], v[234:235], v[44:47]
  s_waitcnt vmcnt(4)
  v_mfma_f32_16x16x16_bf16 v[40:43], v[118:119], v[236:237], v[40:43]
  v_mfma_f32_16x16x16_bf16 v[44:47], v[118:119], v[238:239], v[44:47]
  s_waitcnt vmcnt(3)
  v_mfma_f32_16x16x16_bf16 v[40:43], v[120:121], v[240:241], v[40:43]
  v_mfma_f32_16x16x16_bf16 v[44:47], v[120:121], v[242:243], v[44:47]
  s_waitcnt vmcnt(2)
  v_mfma_f32_16x16x16_bf16 v[40:43], v[122:123], v[244:245], v[40:43]
  v_mfma_f32_16x16x16_bf16 v[44:47], v[122:123], v[246:247], v[44:47]
  s_waitcnt vmcnt(1)
  v_mfma_f32_16x16x16_bf16 v[40:43], v[124:125], v[248:249], v[40:43]
  v_mfma_f32_16x16x16_bf16 v[44:47], v[124:125], v[250:251], v[44:47]
  s_waitcnt vmcnt(0)
  v_mfma_f32_16x16x16_bf16 v[40:43], v[126:127], v[252:253], v[40:43]
  v_mfma_f32_16x16x16_bf16 v[44:47], v[126:127], v[254:255], v[44:47]
  s_nop 5
  s_mov_b64 exec, 0xffff
  v_cvt_pk_bf16_f32 v40, v40, v41
  v_cvt_pk_bf16_f32 v41, v42, v43
  v_cvt_pk_bf16_f32 v42, v44, v45
  v_cvt_pk_bf16_f32 v43, v46, v47
  ds_write_b128 v6, v[40:43]
  s_mov_b64 exec, -1
  s_waitcnt lgkmcnt(0)
  s_barrier
  s_cmp_lg_u32 s3, 0
  s_cbranch_scc1 L_red
  v_and_b32 v6, 12, v0
  v_and_b32 v7, 3, v0
  v_lshlrev_b32 v7, 6, v7
  s_movk_i32 s50, 144
  v_mad_u32_u24 v7, v6, s50, v7
  ds_read_b32 v16, v6 offset:2560
  ds_read_b32 v17, v7 offset:3584
  s_and_b32 s51, s31, 3
  s_lshl2_add_u32 s50, s32, s51
  s_lshl_b32 s50, s50, 4
  s_bfe_u32 s51, s2, 0x10005
  s_mul_i32 s51, s51, 9216
  s_add_u32 s50, s50, s51
  s_add_u32 s50, s50, 0x2e0000
  v_mul_u32_u24 v18, 2304, v0
  v_mov_b32 v19, s55
  v_lshrrev_b32 v23, 24, v19
  s_waitcnt lgkmcnt(0)
  v_max_f32_dpp v20, v16, v16 row_ror:4 row_mask:0xf bank_mask:0xf
  s_nop 1
  v_max_f32_dpp v20, v20, v20 row_ror:8 row_mask:0xf bank_mask:0xf
  v_sub_f32 v16, v16, v20
  v_exp_f32 v16, v16
  v_lshlrev_b32 v22, 8, v20
  v_mul_f32 v21, v16, v17
  v_perm_b32 v20, v20, v19, s56
  v_perm_b32 v22, v22, v19, s58
  v_add_f32_dpp v21, v21, v21 quad_perm:[1,0,3,2] row_mask:0xf bank_mask:0xf
  s_nop 1
  v_add_f32_dpp v21, v21, v21 quad_perm:[2,3,0,1] row_mask:0xf bank_mask:0xf
  s_nop 1
  v_add_f32_dpp v21, v21, v21 row_ror:4 row_mask:0xf bank_mask:0xf
  s_nop 1
  v_add_f32_dpp v21, v21, v21 row_ror:8 row_mask:0xf bank_mask:0xf
  v_perm_b32 v21, v21, v19, s57
  s_mov_b64 exec, 0xf
  buffer_store_dwordx4 v[20:23], v18, s[36:39], s50 offen sc1
  s_mov_b64 exec, -1
L_red:
  s_cmp_ge_u32 s2, 64
  s_cbranch_scc1 L_sdone
  v_lshrrev_b32 v6, 3, v0
  v_and_b32 v14, 7, v0
  v_bfe_u32 v8, v0, 4, 1
  v_lshrrev_b32 v9, 5, v0
  v_lshl_add_u32 v8, v8, 1, v9
  v_lshlrev_b32 v10, 3, v0
  s_bfe_u32 s48, s2, 0x10004
  s_bfe_u32 s49, s2, 0x20002
  s_lshl_b32 s44, s48, 11
  s_lshl_b32 s45, s49, 8
  s_add_u32 s44, s44, s45
  s_lshl_b32 s54, s3, 7
  s_mov_b32 s50, 4194304
  s_cmp_ge_u32 s2, 32
  s_cbranch_scc1 L_redb
  v_and_b32 v11, 3, v0
  v_lshlrev_b32 v7, 6, v6
  v_lshl_add_u32 v7, v11, 4, v7
  s_mul_i32 s52, s2, 16640
  s_lshl_b32 s51, s3, 10
  s_add_u32 s52, s52, s51
  s_add_u32 s52, s52, 0x240000
  s_add_u32 s53, s52, 4096
  s_add_u32 s62, s52, 8192
  s_add_u32 s63, s52, 12288
  s_and_b32 s51, s2, 3
  s_mul_i32 s45, s48, 4
  s_add_u32 s51, s51, s45
  s_mul_i32 s51, s51, 2304
  s_lshl_b32 s45, s3, 9
  s_add_u32 s51, s51, s45
  s_add_u32 s51, s51, 0x2e0000
  v_lshl_add_u32 v8, v8, 3, v14
  v_lshl_add_u32 v8, v8, 2, s54
  v_lshrrev_b32 v9, 2, v0
  v_lshlrev_b32 v9, 5, v9
  v_lshl_add_u32 v9, v11, 2, v9
  s_and_b32 s45, s2, 2
  s_lshl_b32 s45, s45, 6
  s_add_u32 s44, s44, s45
  s_and_b32 s45, s2, 1
  s_lshl4_add_u32 s44, s45, s44
  s_barrier
L_rpoll:
  buffer_load_dwordx4 v[40:43], v7, s[36:39], s51 offen sc1
  buffer_load_dwordx4 v[24:27], v3, s[36:39], s52 offen sc1
  buffer_load_dwordx4 v[28:31], v3, s[36:39], s53 offen sc1
  buffer_load_dwordx4 v[32:35], v3, s[36:39], s62 offen sc1
  buffer_load_dwordx4 v[36:39], v3, s[36:39], s63 offen sc1
  s_mov_b64 s[46:47], exec
  s_waitcnt vmcnt(4)
  v_perm_b32 v16, v41, v40, s76
  v_perm_b32 v16, v42, v16, s77
  v_perm_b32 v16, v43, v16, s78
  v_perm_b32 v80, v40, v42, s57
  v_and_b32 v81, s94, v41
  s_waitcnt vmcnt(3)
  v_perm_b32 v17, v25, v24, s76
  v_perm_b32 v17, v26, v17, s77
  v_perm_b32 v17, v27, v17, s78
  v_and_b32 v64, s94, v24
  v_and_b32 v65, s94, v25
  v_and_b32 v66, s94, v26
  v_and_b32 v67, s94, v27
  s_waitcnt vmcnt(2)
  v_perm_b32 v18, v29, v28, s76
  v_perm_b32 v18, v30, v18, s77
  v_perm_b32 v18, v31, v18, s78
  v_and_b32 v68, s94, v28
  v_and_b32 v69, s94, v29
  v_and_b32 v70, s94, v30
  v_and_b32 v71, s94, v31
  s_waitcnt vmcnt(1)
  v_perm_b32 v19, v33, v32, s76
  v_perm_b32 v19, v34, v19, s77
  v_perm_b32 v19, v35, v19, s78
  v_and_b32 v72, s94, v32
  v_and_b32 v73, s94, v33
  v_and_b32 v74, s94, v34
  v_and_b32 v75, s94, v35
  s_waitcnt vmcnt(0)
  v_perm_b32 v20, v37, v36, s76
  v_perm_b32 v20, v38, v20, s77
  v_perm_b32 v20, v39, v20, s78
  v_and_b32 v76, s94, v36
  v_and_b32 v77, s94, v37
  v_and_b32 v78, s94, v38
  v_and_b32 v79, s94, v39
  v_cmpx_eq_u32 vcc, s55, v16
  v_cmpx_eq_u32 vcc, s55, v17
  v_cmpx_eq_u32 vcc, s55, v18
  v_cmpx_eq_u32 vcc, s55, v19
  v_cmpx_eq_u32 vcc, s55, v20
  s_sub_u32 s50, s50, 1
  s_cbranch_scc1 L_rdone
  s_andn2_b64 exec, s[46:47], vcc
  s_cbranch_scc1 L_rpoll
L_rdone:
  s_mov_b64 exec, -1
  s_nop 1
  v_max_f32_dpp v15, v80, v80 quad_perm:[1,0,3,2] row_mask:0xf bank_mask:0xf
  s_nop 1
  v_max_f32_dpp v15, v15, v15 quad_perm:[2,3,0,1] row_mask:0xf bank_mask:0xf
  v_sub_f32 v16, v80, v15
  v_exp_f32 v16, v16
  s_nop 0
  v_mul_f32 v15, v16, v81
  v_mul_f32_dpp v56, v16, v64 quad_perm:[0,0,0,0] row_mask:0xf bank_mask:0xf
  v_mul_f32_dpp v57, v16, v65 quad_perm:[0,0,0,0] row_mask:0xf bank_mask:0xf
  v_add_f32_dpp v15, v15, v15 quad_perm:[1,0,3,2] row_mask:0xf bank_mask:0xf
  v_mul_f32_dpp v58, v16, v66 quad_perm:[0,0,0,0] row_mask:0xf bank_mask:0xf
  v_mul_f32_dpp v59, v16, v67 quad_perm:[0,0,0,0] row_mask:0xf bank_mask:0xf
  v_add_f32_dpp v15, v15, v15 quad_perm:[2,3,0,1] row_mask:0xf bank_mask:0xf
  v_rcp_f32 v15, v15
  v_fmac_f32_dpp v56, v16, v68 quad_perm:[1,1,1,1] row_mask:0xf bank_mask:0xf
  v_fmac_f32_dpp v57, v16, v69 quad_perm:[1,1,1,1] row_mask:0xf bank_mask:0xf
  v_fmac_f32_dpp v58, v16, v70 quad_perm:[1,1,1,1] row_mask:0xf bank_mask:0xf
  v_fmac_f32_dpp v59, v16, v71 quad_perm:[1,1,1,1] row_mask:0xf bank_mask:0xf
  v_fmac_f32_dpp v56, v16, v72 quad_perm:[2,2,2,2] row_mask:0xf bank_mask:0xf
  v_fmac_f32_dpp v57, v16, v73 quad_perm:[2,2,2,2] row_mask:0xf bank_mask:0xf
  v_fmac_f32_dpp v58, v16, v74 quad_perm:[2,2,2,2] row_mask:0xf bank_mask:0xf
  v_fmac_f32_dpp v59, v16, v75 quad_perm:[2,2,2,2] row_mask:0xf bank_mask:0xf
  v_fmac_f32_dpp v56, v16, v76 quad_perm:[3,3,3,3] row_mask:0xf bank_mask:0xf
  v_fmac_f32_dpp v57, v16, v77 quad_perm:[3,3,3,3] row_mask:0xf bank_mask:0xf
  v_fmac_f32_dpp v58, v16, v78 quad_perm:[3,3,3,3] row_mask:0xf bank_mask:0xf
  v_fmac_f32_dpp v59, v16, v79 quad_perm:[3,3,3,3] row_mask:0xf bank_mask:0xf
  v_mul_f32 v56, v15, v56
  v_mul_f32 v57, v15, v57
  v_mul_f32 v58, v15, v58
  v_mul_f32 v59, v15, v59
L_rsum:
  s_nop 0
  v_permlane32_swap_b32 v56, v57
  v_permlane32_swap_b32 v58, v59
  v_add_f32 v56, v56, v57
  v_add_f32 v58, v58, v59
  s_nop 1
  v_permlane16_swap_b32 v56, v58
  v_add_f32 v56, v56, v58
  s_nop 1
  v_add_f32_dpp v56, v56, v56 row_ror:8 row_mask:0xf bank_mask:0xf
  ds_write_b32 v8, v56 offset:2624
  s_waitcnt lgkmcnt(0)
  s_barrier
  s_cmp_lg_u32 s3, 0
  s_cbranch_scc1 L_sdone
  s_mov_b64 exec, 0xffff
  ds_read_b64 v[60:61], v10 offset:2624
  ds_read_b64 v[62:63], v10 offset:2752
  ds_read_b64 v[64:65], v10 offset:2880
  ds_read_b64 v[66:67], v10 offset:3008
  s_waitcnt lgkmcnt(2)
  v_add_f32 v60, v60, v62
  v_add_f32 v61, v61, v63
  s_waitcnt lgkmcnt(0)
  v_add_f32 v64, v64, v66
  v_add_f32 v65, v65, v67
  v_add_f32 v60, v60, v64
  v_add_f32 v61, v61, v65
  v_cvt_pk_bf16_f32 v60, v60, v61
  buffer_store_dword v60, v9, s[40:43], s44 offen
  s_cmp_lg_u32 s2, 32
  s_cbranch_scc1 L_sdone
  s_mov_b32 s50, 0x100000
  v_mov_b32 v61, s55
  v_mul_u32_u24 v62, 0x1100, v0
  s_mov_b64 exec, 0xff
  buffer_store_dword v61, v62, s[36:39], s50 offen sc1
L_sdone:
  s_endpgm
L_redb:
  s_mul_i32 s52, s2, 4352
  s_lshl_b32 s51, s3, 10
  s_add_u32 s52, s52, s51
  s_add_u32 s52, s52, 0x1ae000
  v_lshl_add_u32 v8, v14, 2, v8
  v_lshl_add_u32 v8, v8, 2, s54
  v_lshrrev_b32 v9, 1, v0
  v_lshlrev_b32 v9, 4, v9
  v_and_b32 v11, 1, v0
  v_lshl_add_u32 v9, v11, 2, v9
  s_and_b32 s45, s2, 1
  s_lshl_b32 s45, s45, 7
  s_add_u32 s44, s44, s45
  s_and_b32 s45, s2, 2
  s_lshl2_add_u32 s44, s45, s44
  s_add_u32 s44, s44, 1024
  s_barrier
L_bpoll:
  buffer_load_dwordx4 v[56:59], v3, s[36:39], s52 offen sc1
  s_waitcnt vmcnt(0)
  v_perm_b32 v16, v57, v56, s76
  v_perm_b32 v16, v58, v16, s77
  v_perm_b32 v16, v59, v16, s78
  v_and_b32 v56, s94, v56
  v_and_b32 v57, s94, v57
  v_and_b32 v58, s94, v58
  v_and_b32 v59, s94, v59
  v_cmp_ne_u32 vcc, s55, v16
  s_sub_u32 s50, s50, 1
  s_cbranch_scc1 L_bdone
  s_and_b64 exec, exec, vcc
  s_cbranch_scc1 L_bpoll
L_bdone:
  s_mov_b64 exec, -1
  s_branch L_rsum
L_hb:
  s_cmp_eq_u32 s33, 2
  s_cbranch_scc1 L_balance
  s_cmp_eq_u32 s33, 1
  s_cbranch_scc1 L_agent
  s_getpc_b64 s[52:53]
L_pc160:
  s_sub_u32 s52, s52, L_pc160-concat_heads__mha_block_cached__gqa_block_cached__decode_kernel
  s_subb_u32 s53, s53, 0
  s_lshl_b32 s50, s31, 10
  v_lshl_add_u32 v42, v0, 4, s50
  s_mov_b32 s50, L_last-concat_heads__mha_block_cached__gqa_block_cached__decode_kernel-16
  v_min_u32 v42, s50, v42
  v_mov_b32 v43, s53
  v_add_co_u32 v42, vcc, s52, v42
  s_nop 1
  v_addc_co_u32 v43, vcc, 0, v43, vcc
  s_mov_b32 s50, 11184810
L_p161:
  ds_read_b32 v24, v41 offset:16
  s_waitcnt lgkmcnt(0)
  v_readfirstlane_b32 s51, v24
  s_sub_u32 s50, s50, 1
  s_cbranch_scc1 L_pd161
  s_cmp_ge_u32 s51, 1
  s_cbranch_scc1 L_pd161
  s_sleep 4
  s_branch L_p161
L_pd161:
  ds_read_b32 v63, v41 offset:20
  s_waitcnt lgkmcnt(0)
  v_readfirstlane_b32 s55, v63
  s_branch L_htiles
L_agent:
  s_mov_b32 s50, 11184810
L_p162:
  ds_read_b32 v24, v41 offset:16
  s_waitcnt lgkmcnt(0)
  v_readfirstlane_b32 s51, v24
  s_sub_u32 s50, s50, 1
  s_cbranch_scc1 L_pd162
  s_cmp_ge_u32 s51, 1
  s_cbranch_scc1 L_pd162
  s_sleep 4
  s_branch L_p162
L_pd162:
  ds_read_b32 v63, v41 offset:20
  s_waitcnt lgkmcnt(0)
  v_readfirstlane_b32 s55, v63
  s_lshl_b32 s52, s32, 13
  s_lshl_b32 s51, s54, 7
  s_add_u32 s52, s52, s51
  s_add_u32 s52, s52, 0x301000
  v_bfe_u32 v42, v0, 3, 2
  v_lshlrev_b32 v42, 10, v42
  v_and_b32 v24, 7, v0
  v_lshl_add_u32 v42, v24, 4, v42
  s_mov_b32 s50, 3728270
L_p163:
  ds_read_b32 v24, v41 offset:8
  s_waitcnt lgkmcnt(0)
  v_readfirstlane_b32 s51, v24
  s_sub_u32 s50, s50, 1
  s_cbranch_scc1 L_pd163
  s_cmp_ge_u32 s51, 4352
  s_cbranch_scc1 L_pd163
  s_sleep 16
  s_branch L_p163
L_pd163:
  s_mov_b32 s79, 1048576
L_g164:
  s_mov_b32 exec_hi, 0
  buffer_load_dwordx4 v[8:11], v42, s[44:47], s52 offen sc1
  s_waitcnt vmcnt(0)
  v_perm_b32 v16, v9, v8, s76
  v_perm_b32 v16, v10, v16, s77
  v_perm_b32 v16, v11, v16, s78
  v_and_b32 v8, s94, v8
  v_and_b32 v9, s94, v9
  v_and_b32 v10, s94, v10
  v_and_b32 v11, s94, v11
  v_cmp_eq_u32 vcc, s55, v16
  s_nop 0
  s_mov_b32 vcc_hi, vcc_lo
  s_not_b64 s[80:81], vcc
  s_mov_b64 exec, -1
  s_cbranch_scc0 L_gd164
  s_sub_u32 s79, s79, 1
  s_cbranch_scc1 L_gd164
  s_sleep 64
  s_branch L_g164
L_gd164:
  v_add_f32_dpp v8, v8, v8 row_ror:8 row_mask:0xf bank_mask:0xf
  v_add_f32_dpp v9, v9, v9 row_ror:8 row_mask:0xf bank_mask:0xf
  v_add_f32_dpp v10, v10, v10 row_ror:8 row_mask:0xf bank_mask:0xf
  v_add_f32_dpp v11, v11, v11 row_ror:8 row_mask:0xf bank_mask:0xf
  v_mov_b32 v12, v8
  v_mov_b32 v13, v9
  v_mov_b32 v14, v10
  v_mov_b32 v15, v11
  s_nop 0
  v_permlane16_swap_b32 v8, v12
  v_permlane16_swap_b32 v9, v13
  v_permlane16_swap_b32 v10, v14
  v_permlane16_swap_b32 v11, v15
  v_add_f32 v8, v8, v12
  v_add_f32 v9, v9, v13
  v_add_f32 v10, v10, v14
  v_add_f32 v11, v11, v15
  v_perm_b32 v8, v8, v63, s56
  v_perm_b32 v9, v9, v63, s57
  v_perm_b32 v10, v10, v63, s58
  v_perm_b32 v11, v11, v63, s59
  s_lshl3_add_u32 s50, s32, s54
  s_lshl_b32 s50, s50, 7
  s_add_u32 s50, s50, 0x110000
  s_mov_b64 exec, 0xff
  buffer_store_dwordx4 v[8:11], v40, s[44:47], s50 offen sc1
  s_mov_b64 exec, -1
  v_and_b32 v42, 31, v0
  v_lshlrev_b32 v42, 4, v42
  v_lshrrev_b32 v24, 5, v0
  v_lshl_add_u32 v42, v24, 10, v42
  v_lshlrev_b32 v43, 4, v1
  v_lshl_add_u32 v43, v24, 8, v43
  v_and_b32 v24, 1, v2
  v_lshl_add_u32 v43, v24, 3, v43
  s_lshl_b32 s52, s30, 12
  s_lshr_b32 s51, s31, 4
  s_lshl_b32 s51, s51, 9
  s_add_u32 s52, s52, s51
  s_add_u32 s52, s52, 0x110000
  s_mov_b32 s50, 3728270
L_p165:
  ds_read_b32 v24, v41 offset:8
  s_waitcnt lgkmcnt(0)
  v_readfirstlane_b32 s51, v24
  s_sub_u32 s50, s50, 1
  s_cbranch_scc1 L_pd165
  s_cmp_ge_u32 s51, 6400
  s_cbranch_scc1 L_pd165
  s_sleep 16
  s_branch L_p165
L_pd165:
  s_mov_b32 s79, 1048576
L_g166:
  buffer_load_dwordx4 v[8:11], v42, s[44:47], s52 offen sc1
  buffer_load_dwordx4 v[12:15], v42, s[44:47], s52 offen offset:2048 sc1
  s_waitcnt vmcnt(0)
  v_perm_b32 v16, v9, v8, s76
  v_perm_b32 v16, v10, v16, s77
  v_perm_b32 v16, v11, v16, s78
  v_and_b32 v8, s94, v8
  v_and_b32 v9, s94, v9
  v_and_b32 v10, s94, v10
  v_and_b32 v11, s94, v11
  v_perm_b32 v17, v13, v12, s76
  v_perm_b32 v17, v14, v17, s77
  v_perm_b32 v17, v15, v17, s78
  v_and_b32 v12, s94, v12
  v_and_b32 v13, s94, v13
  v_and_b32 v14, s94, v14
  v_and_b32 v15, s94, v15
  v_cmpx_eq_u32 vcc, s55, v16
  v_cmpx_eq_u32 vcc, s55, v17
  s_not_b64 s[80:81], vcc
  s_mov_b64 exec, -1
  s_cbranch_scc0 L_gd166
  s_sub_u32 s79, s79, 1
  s_cbranch_scc1 L_gd166
  s_sleep 64
  s_branch L_g166
L_gd166:
  v_cvt_pk_bf16_f32 v16, v8, v9
  v_cvt_pk_bf16_f32 v17, v10, v11
  v_cvt_pk_bf16_f32 v18, v12, v13
  v_cvt_pk_bf16_f32 v19, v14, v15
  ds_write_b64 v43, v[16:17] offset:1024
  ds_write_b64 v43, v[18:19] offset:1536
  s_mov_b32 s50, 3728270
L_p167:
  ds_read_b32 v24, v41 offset:24
  s_waitcnt lgkmcnt(0)
  v_readfirstlane_b32 s51, v24
  s_sub_u32 s50, s50, 1
  s_cbranch_scc1 L_pd167
  s_cmp_ge_u32 s51, 2
  s_cbranch_scc1 L_pd167
  s_sleep 16
  s_branch L_p167
L_pd167:
  v_mov_b32 v25, 1
  ds_write_b32 v41, v25
  s_mov_b32 s50, 3728270
L_p168:
  ds_read_b32 v24, v41 offset:4
  s_waitcnt lgkmcnt(0)
  v_readfirstlane_b32 s51, v24
  s_sub_u32 s50, s50, 1
  s_cbranch_scc1 L_pd168
  s_cmp_ge_u32 s51, 256
  s_cbranch_scc1 L_pd168
  s_sleep 16
  s_branch L_p168
L_pd168:
  v_lshlrev_b32 v42, 4, v2
  v_lshlrev_b32 v43, 5, v0
  ds_read_b32 v8, v42 offset:8192
  ds_read_b32 v9, v42 offset:10752
  ds_read_b32 v10, v42 offset:13312
  ds_read_b32 v11, v42 offset:15872
  s_waitcnt lgkmcnt(0)
  ds_read_b32 v12, v42 offset:8448
  ds_read_b32 v13, v42 offset:8512
  ds_read_b32 v14, v42 offset:8576
  ds_read_b32 v15, v42 offset:8640
  s_waitcnt lgkmcnt(0)
  ds_read_b32 v16, v42 offset:11008
  ds_read_b32 v17, v42 offset:11072
  ds_read_b32 v18, v42 offset:11136
  ds_read_b32 v19, v42 offset:11200
  s_waitcnt lgkmcnt(0)
  ds_read_b32 v20, v42 offset:13568
  ds_read_b32 v21, v42 offset:13632
  ds_read_b32 v22, v42 offset:13696
  ds_read_b32 v23, v42 offset:13760
  s_waitcnt lgkmcnt(0)
  ds_read_b32 v24, v42 offset:16128
  ds_read_b32 v25, v42 offset:16192
  ds_read_b32 v26, v42 offset:16256
  ds_read_b32 v27, v42 offset:16320
  s_waitcnt lgkmcnt(0)
  v_max3_f32 v44, v8, v9, v10
  v_max_f32 v44, v44, v11
  v_sub_f32 v8, v8, v44
  v_sub_f32 v9, v9, v44
  v_sub_f32 v10, v10, v44
  v_sub_f32 v11, v11, v44
  v_exp_f32 v8, v8
  v_exp_f32 v9, v9
  v_exp_f32 v10, v10
  v_exp_f32 v11, v11
  v_mov_b32 v45, 0
  v_lshlrev_b32 v46, 8, v44
  v_mov_b32 v47, 0
  v_fmac_f32 v45, v8, v12
  v_fmac_f32 v45, v8, v13
  v_fmac_f32 v45, v8, v14
  v_fmac_f32 v45, v8, v15
  v_fmac_f32 v45, v9, v16
  v_fmac_f32 v45, v9, v17
  v_fmac_f32 v45, v9, v18
  v_fmac_f32 v45, v9, v19
  v_fmac_f32 v45, v10, v20
  v_fmac_f32 v45, v10, v21
  v_fmac_f32 v45, v10, v22
  v_fmac_f32 v45, v10, v23
  v_fmac_f32 v45, v11, v24
  v_fmac_f32 v45, v11, v25
  v_fmac_f32 v45, v11, v26
  v_fmac_f32 v45, v11, v27
  v_perm_b32 v44, v44, v63, s56
  v_perm_b32 v45, v45, v63, s57
  v_perm_b32 v46, v46, v63, s58
  v_perm_b32 v47, v47, v63, s59
  v_mov_b32 v48, 0
  v_mov_b32 v49, 0
  v_mov_b32 v50, 0
  v_mov_b32 v51, 0
  v_mov_b32 v52, 0
  v_mov_b32 v53, 0
  v_mov_b32 v54, 0
  v_mov_b32 v55, 0
  ds_read_b128 v[12:15], v43 offset:6144
  ds_read_b128 v[16:19], v43 offset:6160
  s_waitcnt lgkmcnt(0)
  v_fmac_f32 v48, v8, v12
  v_fmac_f32 v49, v8, v13
  v_fmac_f32 v50, v8, v14
  v_fmac_f32 v51, v8, v15
  v_fmac_f32 v52, v8, v16
  v_fmac_f32 v53, v8, v17
  v_fmac_f32 v54, v8, v18
  v_fmac_f32 v55, v8, v19
  ds_read_b128 v[12:15], v43 offset:8704
  ds_read_b128 v[16:19], v43 offset:8720
  s_waitcnt lgkmcnt(0)
  v_fmac_f32 v48, v9, v12
  v_fmac_f32 v49, v9, v13
  v_fmac_f32 v50, v9, v14
  v_fmac_f32 v51, v9, v15
  v_fmac_f32 v52, v9, v16
  v_fmac_f32 v53, v9, v17
  v_fmac_f32 v54, v9, v18
  v_fmac_f32 v55, v9, v19
  ds_read_b128 v[12:15], v43 offset:11264
  ds_read_b128 v[16:19], v43 offset:11280
  s_waitcnt lgkmcnt(0)
  v_fmac_f32 v48, v10, v12
  v_fmac_f32 v49, v10, v13
  v_fmac_f32 v50, v10, v14
  v_fmac_f32 v51, v10, v15
  v_fmac_f32 v52, v10, v16
  v_fmac_f32 v53, v10, v17
  v_fmac_f32 v54, v10, v18
  v_fmac_f32 v55, v10, v19
  ds_read_b128 v[12:15], v43 offset:13824
  ds_read_b128 v[16:19], v43 offset:13840
  s_waitcnt lgkmcnt(0)
  v_fmac_f32 v48, v11, v12
  v_fmac_f32 v49, v11, v13
  v_fmac_f32 v50, v11, v14
  v_fmac_f32 v51, v11, v15
  v_fmac_f32 v52, v11, v16
  v_fmac_f32 v53, v11, v17
  v_fmac_f32 v54, v11, v18
  v_fmac_f32 v55, v11, v19
  v_cvt_pk_bf16_f32 v48, v48, v49
  v_cvt_pk_bf16_f32 v49, v50, v51
  v_cvt_pk_bf16_f32 v50, v52, v53
  v_cvt_pk_bf16_f32 v51, v54, v55
  s_lshr_b32 s52, s31, 4
  s_lshl3_add_u32 s52, s52, s30
  s_and_b32 s51, s31, 15
  s_lshl4_add_u32 s52, s52, s51
  s_lshl_b32 s50, s52, 10
  s_add_u32 s50, s50, 0x140000
  buffer_store_dwordx4 v[48:51], v40, s[44:47], s50 offen sc1
  s_lshl_b32 s50, s52, 7
  s_add_u32 s50, s50, 0x1c0000
  v_lshlrev_b32 v42, 5, v2
  v_lshl_add_u32 v42, v1, 4, v42
  s_waitcnt vmcnt(0)
  s_mov_b32 exec_lo, 0x00030003
  s_mov_b32 exec_hi, 0x00030003
  buffer_store_dwordx4 v[44:47], v42, s[44:47], s50 offen sc1
  s_mov_b64 exec, -1
  s_cmp_lt_u32 s54, 4
  s_cbranch_scc1 L_htiles
  v_lshrrev_b32 v42, 5, v0
  v_lshlrev_b32 v43, 14, v42
  v_lshl_add_u32 v43, v1, 7, v43
  v_and_b32 v47, 1, v2
  v_lshlrev_b32 v35, 17, v42
  v_lshl_add_u32 v35, v47, 10, v35
  v_lshl_add_u32 v35, v1, 4, v35
  v_lshl_add_u32 v33, v42, 5, v47
  v_lshlrev_b32 v33, 2, v33
  s_lshr_b32 s51, s31, 3
  s_lshl_b32 s52, s30, 11
  s_lshl_b32 s53, s51, 5
  s_add_u32 s52, s52, s53
  s_add_u32 s52, s52, 0x1c0000
  s_lshl_b32 s53, s30, 14
  s_lshl_b32 s51, s51, 8
  s_add_u32 s53, s53, s51
  s_add_u32 s53, s53, 0x140000
  s_mov_b32 s50, 3728270
L_p169:
  ds_read_b32 v24, v41 offset:8
  s_waitcnt lgkmcnt(0)
  v_readfirstlane_b32 s51, v24
  s_sub_u32 s50, s50, 1
  s_cbranch_scc1 L_pd169
  s_cmp_ge_u32 s51, 14592
  s_cbranch_scc1 L_pd169
  s_sleep 16
  s_branch L_p169
L_pd169:
  s_mov_b32 s79, 1048576
L_g170:
  buffer_load_dwordx4 v[8:11], v43, s[44:47], s52 offen sc1
  s_waitcnt vmcnt(0)
  v_perm_b32 v16, v9, v8, s76
  v_perm_b32 v16, v10, v16, s77
  v_perm_b32 v16, v11, v16, s78
  v_and_b32 v8, s94, v8
  v_and_b32 v9, s94, v9
  v_perm_b32 v8, v8, v10, s57
  v_cmp_eq_u32 vcc, s55, v16
  s_not_b64 s[80:81], vcc
  s_mov_b64 exec, -1
  s_cbranch_scc0 L_gd170
  s_sub_u32 s79, s79, 1
  s_cbranch_scc1 L_gd170
  s_sleep 64
  s_branch L_g170
L_gd170:
  buffer_load_dwordx4 v[192:195], v35, s[44:47], s53 offen offset:0 sc1
  buffer_load_dwordx4 v[196:199], v35, s[44:47], s53 offen offset:2048 sc1
  s_addk_i32 s53, 0x1000
  buffer_load_dwordx4 v[200:203], v35, s[44:47], s53 offen offset:0 sc1
  buffer_load_dwordx4 v[204:207], v35, s[44:47], s53 offen offset:2048 sc1
  s_addk_i32 s53, 0x1000
  buffer_load_dwordx4 v[208:211], v35, s[44:47], s53 offen offset:0 sc1
  buffer_load_dwordx4 v[212:215], v35, s[44:47], s53 offen offset:2048 sc1
  s_addk_i32 s53, 0x1000
  buffer_load_dwordx4 v[216:219], v35, s[44:47], s53 offen offset:0 sc1
  buffer_load_dwordx4 v[220:223], v35, s[44:47], s53 offen offset:2048 sc1
  v_max_f32_dpp v12, v8, v8 quad_perm:[1,0,3,2] row_mask:0xf bank_mask:0xf
  s_nop 1
  v_max_f32_dpp v12, v12, v12 quad_perm:[2,3,0,1] row_mask:0xf bank_mask:0xf
  s_nop 1
  v_max_f32_dpp v12, v12, v12 row_ror:4 row_mask:0xf bank_mask:0xf
  s_nop 1
  v_max_f32_dpp v12, v12, v12 row_ror:8 row_mask:0xf bank_mask:0xf
  s_nop 1
  v_sub_f32 v8, v8, v12
  v_exp_f32 v8, v8
  s_nop 0
  v_mul_f32 v9, v8, v9
  s_nop 1
  v_add_f32_dpp v9, v9, v9 quad_perm:[1,0,3,2] row_mask:0xf bank_mask:0xf
  s_nop 1
  v_add_f32_dpp v9, v9, v9 quad_perm:[2,3,0,1] row_mask:0xf bank_mask:0xf
  s_nop 1
  v_add_f32_dpp v9, v9, v9 row_ror:4 row_mask:0xf bank_mask:0xf
  s_nop 1
  v_add_f32_dpp v9, v9, v9 row_ror:8 row_mask:0xf bank_mask:0xf
  s_nop 1
  v_rcp_f32 v9, v9
  s_nop 0
  v_mul_f32 v8, v8, v9
  ds_bpermute_b32 v48, v33, v8 offset:0
  ds_bpermute_b32 v49, v33, v8 offset:8
  ds_bpermute_b32 v50, v33, v8 offset:16
  ds_bpermute_b32 v51, v33, v8 offset:24
  ds_bpermute_b32 v52, v33, v8 offset:32
  ds_bpermute_b32 v53, v33, v8 offset:40
  ds_bpermute_b32 v54, v33, v8 offset:48
  ds_bpermute_b32 v55, v33, v8 offset:56
  v_mov_b32 v16, 0
  v_mov_b32 v17, 0
  v_mov_b32 v18, 0
  v_mov_b32 v19, 0
  v_mov_b32 v20, 0
  v_mov_b32 v21, 0
  v_mov_b32 v22, 0
  v_mov_b32 v23, 0
  s_waitcnt vmcnt(0) lgkmcnt(0)
  v_lshlrev_b32 v24, 16, v192
  v_and_b32 v25, 0xffff0000, v192
  v_fmac_f32 v16, v48, v24
  v_fmac_f32 v17, v48, v25
  v_lshlrev_b32 v24, 16, v193
  v_and_b32 v25, 0xffff0000, v193
  v_fmac_f32 v18, v48, v24
  v_fmac_f32 v19, v48, v25
  v_lshlrev_b32 v24, 16, v194
  v_and_b32 v25, 0xffff0000, v194
  v_fmac_f32 v20, v48, v24
  v_fmac_f32 v21, v48, v25
  v_lshlrev_b32 v24, 16, v195
  v_and_b32 v25, 0xffff0000, v195
  v_fmac_f32 v22, v48, v24
  v_fmac_f32 v23, v48, v25
  v_lshlrev_b32 v24, 16, v196
  v_and_b32 v25, 0xffff0000, v196
  v_fmac_f32 v16, v49, v24
  v_fmac_f32 v17, v49, v25
  v_lshlrev_b32 v24, 16, v197
  v_and_b32 v25, 0xffff0000, v197
  v_fmac_f32 v18, v49, v24
  v_fmac_f32 v19, v49, v25
  v_lshlrev_b32 v24, 16, v198
  v_and_b32 v25, 0xffff0000, v198
  v_fmac_f32 v20, v49, v24
  v_fmac_f32 v21, v49, v25
  v_lshlrev_b32 v24, 16, v199
  v_and_b32 v25, 0xffff0000, v199
  v_fmac_f32 v22, v49, v24
  v_fmac_f32 v23, v49, v25
  v_lshlrev_b32 v24, 16, v200
  v_and_b32 v25, 0xffff0000, v200
  v_fmac_f32 v16, v50, v24
  v_fmac_f32 v17, v50, v25
  v_lshlrev_b32 v24, 16, v201
  v_and_b32 v25, 0xffff0000, v201
  v_fmac_f32 v18, v50, v24
  v_fmac_f32 v19, v50, v25
  v_lshlrev_b32 v24, 16, v202
  v_and_b32 v25, 0xffff0000, v202
  v_fmac_f32 v20, v50, v24
  v_fmac_f32 v21, v50, v25
  v_lshlrev_b32 v24, 16, v203
  v_and_b32 v25, 0xffff0000, v203
  v_fmac_f32 v22, v50, v24
  v_fmac_f32 v23, v50, v25
  v_lshlrev_b32 v24, 16, v204
  v_and_b32 v25, 0xffff0000, v204
  v_fmac_f32 v16, v51, v24
  v_fmac_f32 v17, v51, v25
  v_lshlrev_b32 v24, 16, v205
  v_and_b32 v25, 0xffff0000, v205
  v_fmac_f32 v18, v51, v24
  v_fmac_f32 v19, v51, v25
  v_lshlrev_b32 v24, 16, v206
  v_and_b32 v25, 0xffff0000, v206
  v_fmac_f32 v20, v51, v24
  v_fmac_f32 v21, v51, v25
  v_lshlrev_b32 v24, 16, v207
  v_and_b32 v25, 0xffff0000, v207
  v_fmac_f32 v22, v51, v24
  v_fmac_f32 v23, v51, v25
  v_lshlrev_b32 v24, 16, v208
  v_and_b32 v25, 0xffff0000, v208
  v_fmac_f32 v16, v52, v24
  v_fmac_f32 v17, v52, v25
  v_lshlrev_b32 v24, 16, v209
  v_and_b32 v25, 0xffff0000, v209
  v_fmac_f32 v18, v52, v24
  v_fmac_f32 v19, v52, v25
  v_lshlrev_b32 v24, 16, v210
  v_and_b32 v25, 0xffff0000, v210
  v_fmac_f32 v20, v52, v24
  v_fmac_f32 v21, v52, v25
  v_lshlrev_b32 v24, 16, v211
  v_and_b32 v25, 0xffff0000, v211
  v_fmac_f32 v22, v52, v24
  v_fmac_f32 v23, v52, v25
  v_lshlrev_b32 v24, 16, v212
  v_and_b32 v25, 0xffff0000, v212
  v_fmac_f32 v16, v53, v24
  v_fmac_f32 v17, v53, v25
  v_lshlrev_b32 v24, 16, v213
  v_and_b32 v25, 0xffff0000, v213
  v_fmac_f32 v18, v53, v24
  v_fmac_f32 v19, v53, v25
  v_lshlrev_b32 v24, 16, v214
  v_and_b32 v25, 0xffff0000, v214
  v_fmac_f32 v20, v53, v24
  v_fmac_f32 v21, v53, v25
  v_lshlrev_b32 v24, 16, v215
  v_and_b32 v25, 0xffff0000, v215
  v_fmac_f32 v22, v53, v24
  v_fmac_f32 v23, v53, v25
  v_lshlrev_b32 v24, 16, v216
  v_and_b32 v25, 0xffff0000, v216
  v_fmac_f32 v16, v54, v24
  v_fmac_f32 v17, v54, v25
  v_lshlrev_b32 v24, 16, v217
  v_and_b32 v25, 0xffff0000, v217
  v_fmac_f32 v18, v54, v24
  v_fmac_f32 v19, v54, v25
  v_lshlrev_b32 v24, 16, v218
  v_and_b32 v25, 0xffff0000, v218
  v_fmac_f32 v20, v54, v24
  v_fmac_f32 v21, v54, v25
  v_lshlrev_b32 v24, 16, v219
  v_and_b32 v25, 0xffff0000, v219
  v_fmac_f32 v22, v54, v24
  v_fmac_f32 v23, v54, v25
  v_lshlrev_b32 v24, 16, v220
  v_and_b32 v25, 0xffff0000, v220
  v_fmac_f32 v16, v55, v24
  v_fmac_f32 v17, v55, v25
  v_lshlrev_b32 v24, 16, v221
  v_and_b32 v25, 0xffff0000, v221
  v_fmac_f32 v18, v55, v24
  v_fmac_f32 v19, v55, v25
  v_lshlrev_b32 v24, 16, v222
  v_and_b32 v25, 0xffff0000, v222
  v_fmac_f32 v20, v55, v24
  v_fmac_f32 v21, v55, v25
  v_lshlrev_b32 v24, 16, v223
  v_and_b32 v25, 0xffff0000, v223
  v_fmac_f32 v22, v55, v24
  v_fmac_f32 v23, v55, v25
  s_nop 1
  v_permlane16_swap_b32 v16, v20
  v_permlane16_swap_b32 v17, v21
  v_permlane16_swap_b32 v18, v22
  v_permlane16_swap_b32 v19, v23
  v_add_f32 v16, v16, v20
  v_add_f32 v17, v17, v21
  v_add_f32 v18, v18, v22
  v_add_f32 v19, v19, v23
  v_cvt_pk_bf16_f32 v16, v16, v17
  v_cvt_pk_bf16_f32 v17, v18, v19
  v_lshl_add_u32 v46, v1, 1, v47
  v_lshlrev_b32 v46, 1, v46
  v_lshl_add_u32 v46, v42, 8, v46
  ds_write_b16 v46, v16 offset:256
  ds_write_b16_d16_hi v46, v16 offset:320
  ds_write_b16 v46, v17 offset:384
  ds_write_b16_d16_hi v46, v17 offset:448
  v_lshlrev_b32 v46, 8, v34
  v_lshl_add_u32 v46, v2, 6, v46
  s_waitcnt lgkmcnt(0)
  ds_read_b128 v[8:11], v46 offset:256
  ds_read_b128 v[12:15], v46 offset:272
  ds_read_b128 v[16:19], v46 offset:288
  ds_read_b128 v[20:23], v46 offset:304
  s_waitcnt lgkmcnt(0)
  s_mov_b32 s52, 0x01000100
  s_mov_b32 s53, 0x03020302
  v_perm_b32 v32, v8, v8, s52
  v_and_b32 v24, v32, v4
  v_and_b32 v25, v32, v5
  v_and_b32 v26, v32, v6
  v_and_b32 v27, v32, v7
  s_nop 1
  v_mfma_f32_16x16x32_bf16 v[56:59], v[24:27], v[64:67], 0
  v_perm_b32 v32, v8, v8, s53
  v_and_b32 v24, v32, v4
  v_and_b32 v25, v32, v5
  v_and_b32 v26, v32, v6
  v_and_b32 v27, v32, v7
  s_nop 1
  v_mfma_f32_16x16x32_bf16 v[56:59], v[24:27], v[68:71], v[56:59]
  v_perm_b32 v32, v9, v9, s52
  v_and_b32 v24, v32, v4
  v_and_b32 v25, v32, v5
  v_and_b32 v26, v32, v6
  v_and_b32 v27, v32, v7
  s_nop 1
  v_mfma_f32_16x16x32_bf16 v[56:59], v[24:27], v[72:75], v[56:59]
  v_perm_b32 v32, v9, v9, s53
  v_and_b32 v24, v32, v4
  v_and_b32 v25, v32, v5
  v_and_b32 v26, v32, v6
  v_and_b32 v27, v32, v7
  s_nop 1
  v_mfma_f32_16x16x32_bf16 v[56:59], v[24:27], v[76:79], v[56:59]
  v_perm_b32 v32, v10, v10, s52
  v_and_b32 v24, v32, v4
  v_and_b32 v25, v32, v5
  v_and_b32 v26, v32, v6
  v_and_b32 v27, v32, v7
  s_nop 1
  v_mfma_f32_16x16x32_bf16 v[56:59], v[24:27], v[80:83], v[56:59]
  v_perm_b32 v32, v10, v10, s53
  v_and_b32 v24, v32, v4
  v_and_b32 v25, v32, v5
  v_and_b32 v26, v32, v6
  v_and_b32 v27, v32, v7
  s_nop 1
  v_mfma_f32_16x16x32_bf16 v[56:59], v[24:27], v[84:87], v[56:59]
  v_perm_b32 v32, v11, v11, s52
  v_and_b32 v24, v32, v4
  v_and_b32 v25, v32, v5
  v_and_b32 v26, v32, v6
  v_and_b32 v27, v32, v7
  s_nop 1
  v_mfma_f32_16x16x32_bf16 v[56:59], v[24:27], v[88:91], v[56:59]
  v_perm_b32 v32, v11, v11, s53
  v_and_b32 v24, v32, v4
  v_and_b32 v25, v32, v5
  v_and_b32 v26, v32, v6
  v_and_b32 v27, v32, v7
  s_nop 1
  v_mfma_f32_16x16x32_bf16 v[56:59], v[24:27], v[92:95], v[56:59]
  v_perm_b32 v32, v12, v12, s52
  v_and_b32 v24, v32, v4
  v_and_b32 v25, v32, v5
  v_and_b32 v26, v32, v6
  v_and_b32 v27, v32, v7
  s_nop 1
  v_mfma_f32_16x16x32_bf16 v[56:59], v[24:27], v[96:99], v[56:59]
  v_perm_b32 v32, v12, v12, s53
  v_and_b32 v24, v32, v4
  v_and_b32 v25, v32, v5
  v_and_b32 v26, v32, v6
  v_and_b32 v27, v32, v7
  s_nop 1
  v_mfma_f32_16x16x32_bf16 v[56:59], v[24:27], v[100:103], v[56:59]
  v_perm_b32 v32, v13, v13, s52
  v_and_b32 v24, v32, v4
  v_and_b32 v25, v32, v5
  v_and_b32 v26, v32, v6
  v_and_b32 v27, v32, v7
  s_nop 1
  v_mfma_f32_16x16x32_bf16 v[56:59], v[24:27], v[104:107], v[56:59]
  v_perm_b32 v32, v13, v13, s53
  v_and_b32 v24, v32, v4
  v_and_b32 v25, v32, v5
  v_and_b32 v26, v32, v6
  v_and_b32 v27, v32, v7
  s_nop 1
  v_mfma_f32_16x16x32_bf16 v[56:59], v[24:27], v[108:111], v[56:59]
  v_perm_b32 v32, v14, v14, s52
  v_and_b32 v24, v32, v4
  v_and_b32 v25, v32, v5
  v_and_b32 v26, v32, v6
  v_and_b32 v27, v32, v7
  s_nop 1
  v_mfma_f32_16x16x32_bf16 v[56:59], v[24:27], v[112:115], v[56:59]
  v_perm_b32 v32, v14, v14, s53
  v_and_b32 v24, v32, v4
  v_and_b32 v25, v32, v5
  v_and_b32 v26, v32, v6
  v_and_b32 v27, v32, v7
  s_nop 1
  v_mfma_f32_16x16x32_bf16 v[56:59], v[24:27], v[116:119], v[56:59]
  v_perm_b32 v32, v15, v15, s52
  v_and_b32 v24, v32, v4
  v_and_b32 v25, v32, v5
  v_and_b32 v26, v32, v6
  v_and_b32 v27, v32, v7
  s_nop 1
  v_mfma_f32_16x16x32_bf16 v[56:59], v[24:27], v[120:123], v[56:59]
  v_perm_b32 v32, v15, v15, s53
  v_and_b32 v24, v32, v4
  v_and_b32 v25, v32, v5
  v_and_b32 v26, v32, v6
  v_and_b32 v27, v32, v7
  s_nop 1
  v_mfma_f32_16x16x32_bf16 v[56:59], v[24:27], v[124:127], v[56:59]
  v_perm_b32 v32, v16, v16, s52
  v_and_b32 v24, v32, v4
  v_and_b32 v25, v32, v5
  v_and_b32 v26, v32, v6
  v_and_b32 v27, v32, v7
  s_nop 1
  v_mfma_f32_16x16x32_bf16 v[56:59], v[24:27], v[128:131], v[56:59]
  v_perm_b32 v32, v16, v16, s53
  v_and_b32 v24, v32, v4
  v_and_b32 v25, v32, v5
  v_and_b32 v26, v32, v6
  v_and_b32 v27, v32, v7
  s_nop 1
  v_mfma_f32_16x16x32_bf16 v[56:59], v[24:27], v[132:135], v[56:59]
  v_perm_b32 v32, v17, v17, s52
  v_and_b32 v24, v32, v4
  v_and_b32 v25, v32, v5
  v_and_b32 v26, v32, v6
  v_and_b32 v27, v32, v7
  s_nop 1
  v_mfma_f32_16x16x32_bf16 v[56:59], v[24:27], v[136:139], v[56:59]
  v_perm_b32 v32, v17, v17, s53
  v_and_b32 v24, v32, v4
  v_and_b32 v25, v32, v5
  v_and_b32 v26, v32, v6
  v_and_b32 v27, v32, v7
  s_nop 1
  v_mfma_f32_16x16x32_bf16 v[56:59], v[24:27], v[140:143], v[56:59]
  v_perm_b32 v32, v18, v18, s52
  v_and_b32 v24, v32, v4
  v_and_b32 v25, v32, v5
  v_and_b32 v26, v32, v6
  v_and_b32 v27, v32, v7
  s_nop 1
  v_mfma_f32_16x16x32_bf16 v[56:59], v[24:27], v[144:147], v[56:59]
  v_perm_b32 v32, v18, v18, s53
  v_and_b32 v24, v32, v4
  v_and_b32 v25, v32, v5
  v_and_b32 v26, v32, v6
  v_and_b32 v27, v32, v7
  s_nop 1
  v_mfma_f32_16x16x32_bf16 v[56:59], v[24:27], v[148:151], v[56:59]
  v_perm_b32 v32, v19, v19, s52
  v_and_b32 v24, v32, v4
  v_and_b32 v25, v32, v5
  v_and_b32 v26, v32, v6
  v_and_b32 v27, v32, v7
  s_nop 1
  v_mfma_f32_16x16x32_bf16 v[56:59], v[24:27], v[152:155], v[56:59]
  v_perm_b32 v32, v19, v19, s53
  v_and_b32 v24, v32, v4
  v_and_b32 v25, v32, v5
  v_and_b32 v26, v32, v6
  v_and_b32 v27, v32, v7
  s_nop 1
  v_mfma_f32_16x16x32_bf16 v[56:59], v[24:27], v[156:159], v[56:59]
  v_perm_b32 v32, v20, v20, s52
  v_and_b32 v24, v32, v4
  v_and_b32 v25, v32, v5
  v_and_b32 v26, v32, v6
  v_and_b32 v27, v32, v7
  s_nop 1
  v_mfma_f32_16x16x32_bf16 v[56:59], v[24:27], v[160:163], v[56:59]
  v_perm_b32 v32, v20, v20, s53
  v_and_b32 v24, v32, v4
  v_and_b32 v25, v32, v5
  v_and_b32 v26, v32, v6
  v_and_b32 v27, v32, v7
  s_nop 1
  v_mfma_f32_16x16x32_bf16 v[56:59], v[24:27], v[164:167], v[56:59]
  v_perm_b32 v32, v21, v21, s52
  v_and_b32 v24, v32, v4
  v_and_b32 v25, v32, v5
  v_and_b32 v26, v32, v6
  v_and_b32 v27, v32, v7
  s_nop 1
  v_mfma_f32_16x16x32_bf16 v[56:59], v[24:27], v[168:171], v[56:59]
  v_perm_b32 v32, v21, v21, s53
  v_and_b32 v24, v32, v4
  v_and_b32 v25, v32, v5
  v_and_b32 v26, v32, v6
  v_and_b32 v27, v32, v7
  s_nop 1
  v_mfma_f32_16x16x32_bf16 v[56:59], v[24:27], v[172:175], v[56:59]
  v_perm_b32 v32, v22, v22, s52
  v_and_b32 v24, v32, v4
  v_and_b32 v25, v32, v5
  v_and_b32 v26, v32, v6
  v_and_b32 v27, v32, v7
  s_nop 1
  v_mfma_f32_16x16x32_bf16 v[56:59], v[24:27], v[176:179], v[56:59]
  v_perm_b32 v32, v22, v22, s53
  v_and_b32 v24, v32, v4
  v_and_b32 v25, v32, v5
  v_and_b32 v26, v32, v6
  v_and_b32 v27, v32, v7
  s_nop 1
  v_mfma_f32_16x16x32_bf16 v[56:59], v[24:27], v[180:183], v[56:59]
  v_perm_b32 v32, v23, v23, s52
  v_and_b32 v24, v32, v4
  v_and_b32 v25, v32, v5
  v_and_b32 v26, v32, v6
  v_and_b32 v27, v32, v7
  s_nop 1
  v_mfma_f32_16x16x32_bf16 v[56:59], v[24:27], v[184:187], v[56:59]
  v_perm_b32 v32, v23, v23, s53
  v_and_b32 v24, v32, v4
  v_and_b32 v25, v32, v5
  v_and_b32 v26, v32, v6
  v_and_b32 v27, v32, v7
  s_nop 1
  v_mfma_f32_16x16x32_bf16 v[56:59], v[24:27], v[188:191], v[56:59]
  s_lshl_b32 s52, s32, 7
  s_and_b32 s51, s54, 3
  s_mul_i32 s51, s51, 17408
  s_add_u32 s52, s52, s51
  s_add_u32 s52, s52, 0x1d0000
  v_bfe_u32 v60, v0, 3, 2
  v_lshl_add_u32 v60, v42, 4, v60
  v_mul_u32_u24 v60, 4352, v60
  v_and_b32 v24, 7, v0
  v_lshl_add_u32 v60, v24, 4, v60
  v_perm_b32 v56, v56, v63, s56
  v_perm_b32 v57, v57, v63, s57
  v_perm_b32 v58, v58, v63, s58
  v_perm_b32 v59, v59, v63, s59
L_htiles:
  s_mov_b32 s50, 1973790
L_p171:
  ds_read_b32 v24, v41 offset:24
  s_waitcnt lgkmcnt(0)
  v_readfirstlane_b32 s51, v24
  s_sub_u32 s50, s50, 1
  s_cbranch_scc1 L_pd171
  s_cmp_ge_u32 s51, 1
  s_cbranch_scc1 L_pd171
  s_sleep 32
  s_branch L_p171
L_pd171:
  s_lshl_b32 s50, s33, 15
  s_add_u32 s50, s50, 16384
  v_lshrrev_b32 v33, 2, v1
  v_lshl_add_u32 v33, v2, 3, v33
  v_lshlrev_b32 v33, 8, v33
  v_and_b32 v24, 3, v0
  v_lshl_add_u32 v33, v24, 3, v33
  v_add_u32 v33, s50, v33
  ds_read_b64_tr_b16 v[128:129], v33 offset:0
  ds_read_b64_tr_b16 v[130:131], v33 offset:1024
  ds_read_b64_tr_b16 v[132:133], v33 offset:8192
  ds_read_b64_tr_b16 v[134:135], v33 offset:9216
  ds_read_b64_tr_b16 v[136:137], v33 offset:16384
  ds_read_b64_tr_b16 v[138:139], v33 offset:17408
  ds_read_b64_tr_b16 v[140:141], v33 offset:24576
  ds_read_b64_tr_b16 v[142:143], v33 offset:25600
  s_waitcnt lgkmcnt(0)
  ds_read_b64_tr_b16 v[144:145], v33 offset:32
  ds_read_b64_tr_b16 v[146:147], v33 offset:1056
  ds_read_b64_tr_b16 v[148:149], v33 offset:8224
  ds_read_b64_tr_b16 v[150:151], v33 offset:9248
  ds_read_b64_tr_b16 v[152:153], v33 offset:16416
  ds_read_b64_tr_b16 v[154:155], v33 offset:17440
  ds_read_b64_tr_b16 v[156:157], v33 offset:24608
  ds_read_b64_tr_b16 v[158:159], v33 offset:25632
  s_waitcnt lgkmcnt(0)
  ds_read_b64_tr_b16 v[160:161], v33 offset:64
  ds_read_b64_tr_b16 v[162:163], v33 offset:1088
  ds_read_b64_tr_b16 v[164:165], v33 offset:8256
  ds_read_b64_tr_b16 v[166:167], v33 offset:9280
  ds_read_b64_tr_b16 v[168:169], v33 offset:16448
  ds_read_b64_tr_b16 v[170:171], v33 offset:17472
  ds_read_b64_tr_b16 v[172:173], v33 offset:24640
  ds_read_b64_tr_b16 v[174:175], v33 offset:25664
  s_waitcnt lgkmcnt(0)
  ds_read_b64_tr_b16 v[176:177], v33 offset:96
  ds_read_b64_tr_b16 v[178:179], v33 offset:1120
  ds_read_b64_tr_b16 v[180:181], v33 offset:8288
  ds_read_b64_tr_b16 v[182:183], v33 offset:9312
  ds_read_b64_tr_b16 v[184:185], v33 offset:16480
  ds_read_b64_tr_b16 v[186:187], v33 offset:17504
  ds_read_b64_tr_b16 v[188:189], v33 offset:24672
  ds_read_b64_tr_b16 v[190:191], v33 offset:25696
  s_waitcnt lgkmcnt(0)
  ds_read_b64_tr_b16 v[192:193], v33 offset:128
  ds_read_b64_tr_b16 v[194:195], v33 offset:1152
  ds_read_b64_tr_b16 v[196:197], v33 offset:8320
  ds_read_b64_tr_b16 v[198:199], v33 offset:9344
  ds_read_b64_tr_b16 v[200:201], v33 offset:16512
  ds_read_b64_tr_b16 v[202:203], v33 offset:17536
  ds_read_b64_tr_b16 v[204:205], v33 offset:24704
  ds_read_b64_tr_b16 v[206:207], v33 offset:25728
  s_waitcnt lgkmcnt(0)
  ds_read_b64_tr_b16 v[208:209], v33 offset:160
  ds_read_b64_tr_b16 v[210:211], v33 offset:1184
  ds_read_b64_tr_b16 v[212:213], v33 offset:8352
  ds_read_b64_tr_b16 v[214:215], v33 offset:9376
  ds_read_b64_tr_b16 v[216:217], v33 offset:16544
  ds_read_b64_tr_b16 v[218:219], v33 offset:17568
  ds_read_b64_tr_b16 v[220:221], v33 offset:24736
  ds_read_b64_tr_b16 v[222:223], v33 offset:25760
  s_waitcnt lgkmcnt(0)
  ds_read_b64_tr_b16 v[224:225], v33 offset:192
  ds_read_b64_tr_b16 v[226:227], v33 offset:1216
  ds_read_b64_tr_b16 v[228:229], v33 offset:8384
  ds_read_b64_tr_b16 v[230:231], v33 offset:9408
  ds_read_b64_tr_b16 v[232:233], v33 offset:16576
  ds_read_b64_tr_b16 v[234:235], v33 offset:17600
  ds_read_b64_tr_b16 v[236:237], v33 offset:24768
  ds_read_b64_tr_b16 v[238:239], v33 offset:25792
  s_waitcnt lgkmcnt(0)
  ds_read_b64_tr_b16 v[240:241], v33 offset:224
  ds_read_b64_tr_b16 v[242:243], v33 offset:1248
  ds_read_b64_tr_b16 v[244:245], v33 offset:8416
  ds_read_b64_tr_b16 v[246:247], v33 offset:9440
  ds_read_b64_tr_b16 v[248:249], v33 offset:16608
  ds_read_b64_tr_b16 v[250:251], v33 offset:17632
  ds_read_b64_tr_b16 v[252:253], v33 offset:24800
  ds_read_b64_tr_b16 v[254:255], v33 offset:25824
  s_waitcnt lgkmcnt(0)
  s_cmp_lg_u32 s33, 3
  s_cbranch_scc1 L_hfinal
  s_mov_b32 s50, 3728270
L_p172:
  ds_read_b32 v24, v41 offset:8
  s_waitcnt lgkmcnt(0)
  v_readfirstlane_b32 s51, v24
  s_sub_u32 s50, s50, 1
  s_cbranch_scc1 L_pd172
  s_cmp_ge_u32 s51, 6656
  s_cbranch_scc1 L_pd172
  s_sleep 16
  s_branch L_p172
L_pd172:
  global_load_dwordx4 v[44:47], v[42:43], off
  s_mov_b32 s50, 3728270
L_p173:
  ds_read_b32 v24, v41 offset:8
  s_waitcnt lgkmcnt(0)
  v_readfirstlane_b32 s51, v24
  s_sub_u32 s50, s50, 1
  s_cbranch_scc1 L_pd173
  s_cmp_ge_u32 s51, 16896
  s_cbranch_scc1 L_pd173
  s_sleep 16
  s_branch L_p173
L_pd173:
  global_load_dwordx4 v[44:47], v[42:43], off
L_hfinal:
  v_and_b32 v8, 3, v0
  v_mul_u32_u24 v8, 576, v8
  v_lshl_add_u32 v8, v2, 4, v8
  v_mov_b32 v9, 0
  s_and_b32 s50, s31, 3
  s_lshl_b32 s50, s50, 5
  s_add_u32 s50, s50, s32
  s_lshl_b32 s50, s50, 7
  s_bfe_u32 s51, s2, 0x10005
  s_lshl2_add_u32 s51, s51, s33
  s_mul_i32 s51, s51, 66560
  s_add_u32 s50, s50, s51
  s_add_u32 s50, s50, 0x240000
  s_add_u32 s51, s50, 33280
  v_mul_u32_u24 v10, 16640, v34
  v_and_b32 v11, 7, v0
  v_lshl_add_u32 v10, v11, 4, v10
  v_lshl_add_u32 v10, v2, 28, v10
  s_and_b32 s48, s54, 4
  s_add_u32 s48, s48, s33
  s_waitcnt vmcnt(0) lgkmcnt(0)
  s_barrier
  ds_read_b128 v[16:19], v8 offset:3328
  ds_read_b128 v[20:23], v8 offset:3392
  ds_read_b128 v[24:27], v8 offset:3456
  ds_read_b128 v[28:31], v8 offset:3520
  ds_read_b128 v[12:15], v9 offset:2560
  s_cmp_lg_u32 s48, 5
  s_cbranch_scc1 L_hf2
  buffer_store_dwordx4 v[56:59], v60, s[44:47], s52 offen sc1
L_hf2:
  s_waitcnt lgkmcnt(4)
  v_mfma_f32_16x16x32_bf16 v[64:67], v[16:19], v[128:131], 0
  s_waitcnt lgkmcnt(3)
  v_mfma_f32_16x16x32_bf16 v[64:67], v[20:23], v[132:135], v[64:67]
  s_waitcnt lgkmcnt(2)
  v_mfma_f32_16x16x32_bf16 v[64:67], v[24:27], v[136:139], v[64:67]
  s_waitcnt lgkmcnt(1)
  v_mfma_f32_16x16x32_bf16 v[64:67], v[28:31], v[140:143], v[64:67]
  v_mfma_f32_16x16x32_bf16 v[68:71], v[16:19], v[144:147], 0
  s_waitcnt lgkmcnt(0)
  v_max3_f32 v11, v12, v13, v14
  v_mfma_f32_16x16x32_bf16 v[68:71], v[20:23], v[148:151], v[68:71]
  v_max_f32 v11, v11, v15
  v_sub_f32 v12, v12, v11
  v_mfma_f32_16x16x32_bf16 v[68:71], v[24:27], v[152:155], v[68:71]
  v_sub_f32 v13, v13, v11
  v_sub_f32 v14, v14, v11
  v_mfma_f32_16x16x32_bf16 v[68:71], v[28:31], v[156:159], v[68:71]
  v_sub_f32 v15, v15, v11
  v_exp_f32 v12, v12
  v_mfma_f32_16x16x32_bf16 v[72:75], v[16:19], v[160:163], 0
  v_exp_f32 v13, v13
  v_exp_f32 v14, v14
  v_mfma_f32_16x16x32_bf16 v[72:75], v[20:23], v[164:167], v[72:75]
  v_exp_f32 v15, v15
  v_mul_f32 v32, v12, v64
  v_mfma_f32_16x16x32_bf16 v[72:75], v[24:27], v[168:171], v[72:75]
  v_fmac_f32 v32, v13, v65
  v_fmac_f32 v32, v14, v66
  v_mfma_f32_16x16x32_bf16 v[72:75], v[28:31], v[172:175], v[72:75]
  v_fmac_f32 v32, v15, v67
  v_perm_b32 v32, v32, v63, s56
  v_mfma_f32_16x16x32_bf16 v[76:79], v[16:19], v[176:179], 0
  v_mul_f32 v33, v12, v68
  v_fmac_f32 v33, v13, v69
  v_mfma_f32_16x16x32_bf16 v[76:79], v[20:23], v[180:183], v[76:79]
  v_fmac_f32 v33, v14, v70
  v_fmac_f32 v33, v15, v71
  v_mfma_f32_16x16x32_bf16 v[76:79], v[24:27], v[184:187], v[76:79]
  v_perm_b32 v33, v33, v63, s57
  v_mfma_f32_16x16x32_bf16 v[76:79], v[28:31], v[188:191], v[76:79]
  v_mfma_f32_16x16x32_bf16 v[80:83], v[16:19], v[192:195], 0
  v_mul_f32 v34, v12, v72
  v_fmac_f32 v34, v13, v73
  v_mfma_f32_16x16x32_bf16 v[80:83], v[20:23], v[196:199], v[80:83]
  v_fmac_f32 v34, v14, v74
  v_fmac_f32 v34, v15, v75
  v_mfma_f32_16x16x32_bf16 v[80:83], v[24:27], v[200:203], v[80:83]
  v_perm_b32 v34, v34, v63, s58
  v_mfma_f32_16x16x32_bf16 v[80:83], v[28:31], v[204:207], v[80:83]
  v_mfma_f32_16x16x32_bf16 v[84:87], v[16:19], v[208:211], 0
  v_mul_f32 v35, v12, v76
  v_fmac_f32 v35, v13, v77
  v_mfma_f32_16x16x32_bf16 v[84:87], v[20:23], v[212:215], v[84:87]
  v_fmac_f32 v35, v14, v78
  v_fmac_f32 v35, v15, v79
  v_mfma_f32_16x16x32_bf16 v[84:87], v[24:27], v[216:219], v[84:87]
  v_perm_b32 v35, v35, v63, s59
  buffer_store_dwordx4 v[32:35], v10, s[44:47], s50 offen sc1
  v_mfma_f32_16x16x32_bf16 v[84:87], v[28:31], v[220:223], v[84:87]
  v_mfma_f32_16x16x32_bf16 v[88:91], v[16:19], v[224:227], 0
  v_mul_f32 v36, v12, v80
  v_fmac_f32 v36, v13, v81
  v_mfma_f32_16x16x32_bf16 v[88:91], v[20:23], v[228:231], v[88:91]
  v_fmac_f32 v36, v14, v82
  v_fmac_f32 v36, v15, v83
  v_mfma_f32_16x16x32_bf16 v[88:91], v[24:27], v[232:235], v[88:91]
  v_perm_b32 v36, v36, v63, s56
  v_mfma_f32_16x16x32_bf16 v[88:91], v[28:31], v[236:239], v[88:91]
  v_mfma_f32_16x16x32_bf16 v[92:95], v[16:19], v[240:243], 0
  v_mul_f32 v37, v12, v84
  v_fmac_f32 v37, v13, v85
  v_mfma_f32_16x16x32_bf16 v[92:95], v[20:23], v[244:247], v[92:95]
  v_fmac_f32 v37, v14, v86
  v_fmac_f32 v37, v15, v87
  v_mfma_f32_16x16x32_bf16 v[92:95], v[24:27], v[248:251], v[92:95]
  v_perm_b32 v37, v37, v63, s57
  v_mfma_f32_16x16x32_bf16 v[92:95], v[28:31], v[252:255], v[92:95]
  v_mul_f32 v38, v12, v88
  v_fmac_f32 v38, v13, v89
  v_fmac_f32 v38, v14, v90
  v_fmac_f32 v38, v15, v91
  v_perm_b32 v38, v38, v63, s58
  s_nop 2
  v_mul_f32 v39, v12, v92
  v_fmac_f32 v39, v13, v93
  v_fmac_f32 v39, v14, v94
  v_fmac_f32 v39, v15, v95
  v_perm_b32 v39, v39, v63, s59
  buffer_store_dwordx4 v[36:39], v10, s[44:47], s51 offen sc1
L_end:
  s_endpgm
L_balance:
  s_mul_i32 s52, s30, 4352
  s_add_u32 s52, s52, 0x380000
  s_lshl1_add_u32 s53, s31, s52
  v_lshlrev_b32 v42, 1, v0
  v_mov_b32 v12, 0
  s_cmp_lg_u32 s31, 0
  s_cbranch_scc1 L_pi
  s_mov_b64 exec, 0xff
  buffer_store_dwordx4 v[28:31], v40, s[44:47], s52 offen sc1
  s_cmp_lg_u32 s30, 0
  s_cbranch_scc1 L_pi
  s_mov_b64 exec, -1
  v_mul_u32_u24 v13, 0x1100, v0
  s_mov_b32 s50, 0x390000
  buffer_store_dword v12, v13, s[44:47], s50 offen sc1
L_pi:
  s_mov_b64 exec, -1
  s_mov_b32 s49, 128
  s_mov_b32 s79, 16777216
  s_mov_b32 s60, 0
  s_mov_b32 s61, 0
L_pl:
  ds_read_b32 v24, v41 offset:8
  s_waitcnt lgkmcnt(0)
  v_readfirstlane_b32 s51, v24
  s_sub_i32 s79, s79, 1
  s_cmp_lt_i32 s79, 0
  s_cbranch_scc1 L_pt
  s_cmp_ge_u32 s51, s49
  s_cbranch_scc1 L_pt
  s_sleep 2
  s_branch L_pl
L_pt:
  s_add_u32 s48, s51, 128
  s_lshr_b32 s48, s48, 8
  s_lshl_b32 s49, s48, 8
  s_add_u32 s49, s49, 128
  s_min_u32 s49, s49, 19456
  v_mov_b32 v12, s48
  s_mov_b32 exec_hi, 1
  buffer_load_sshort v13, v42, s[44:47], s52 offen nt
  s_mov_b64 exec, 1
  buffer_store_short v12, off, s[44:47], s53
  s_cmp_lg_u32 s31, 0
  s_cbranch_scc1 L_pn
  s_lshr_b32 s50, s48, 2
  s_cmp_eq_u32 s50, s60
  s_cbranch_scc1 L_pn
  s_mov_b32 s60, s50
  s_mul_i32 s50, s50, 0x1100
  s_add_u32 s50, s50, 0x390000
  v_mov_b32 v14, 2
  buffer_atomic_add v14, off, s[44:47], s50 sc0 sc1
  s_waitcnt vmcnt(0)
  v_readfirstlane_b32 s50, v14
  s_sub_i32 s50, s50, 7
  s_mul_i32 s50, s50, 1
  s_getreg_b32 s51, hwreg(HW_REG_XCC_ID)
  s_bitcmp1_b32 s51, 0
  s_cselect_b32 s51, -2, 2
  s_add_i32 s50, s50, s51
  v_mov_b32 v14, s50
  buffer_store_short v14, off, s[44:47], s52 offset:64
L_pn:
  s_mov_b32 exec_lo, -1
  s_waitcnt vmcnt(1)
  v_readlane_b32 s50, v13, 32
  v_subrev_u32 v13, s48, v13
  v_cmp_le_i32 vcc, -2, v13
  s_bcnt1_i32_b64 s51, vcc
  s_add_i32 s50, s50, s51
  v_cmp_le_i32 vcc, -1, v13
  s_bcnt1_i32_b64 s51, vcc
  s_add_i32 s50, s50, s51
  v_cmp_le_i32 vcc, 0, v13
  s_bcnt1_i32_b64 s51, vcc
  s_add_i32 s50, s50, s51
  v_cmp_le_i32 vcc, 1, v13
  s_bcnt1_i32_b64 s51, vcc
  s_add_i32 s50, s50, s51
  v_cmp_le_i32 vcc, 2, v13
  s_bcnt1_i32_b64 s51, vcc
  s_add_i32 s50, s50, s51
  s_mov_b64 exec, -1
  s_sub_i32 s37, s50, 64
  s_max_i32 s37, s37, 0
  s_lshr_b32 s37, s37, 2
  s_min_u32 s37, s37, 16
  s_bfm_b32 s37, s37, 16
  s_sub_i32 s50, s50, 80
  s_abs_i32 s51, s50
  s_lshr_b32 s51, s51, 2
  s_min_u32 s51, s51, 8
  s_bfm_b32 s51, s51, 0
  s_cmp_lt_i32 s50, 0
  s_cselect_b32 s50, 8, 0
  s_lshl_b32 s51, s51, s50
  s_or_b32 s51, s51, s37
  v_mov_b32 v12, s51
  ds_write_b32 v41, v12 offset:12
  s_cmp_lt_u32 s48, 1
  s_cbranch_scc1 L_pl
  s_cmp_lt_i32 s36, 0
  s_cbranch_scc1 L_pe
  s_cmp_eq_u32 s36, 0
  s_cbranch_scc1 L_pw
L_pd:
  s_lshl_b32 s37, s63, 10
  s_add_u32 m0, s37, 16384
  s_lshl_b32 s50, s63, 12
  s_add_u32 s50, s50, s62
  buffer_load_dwordx4 v33, s[40:43], s50 offen  lds
  s_add_u32 m0, m0, 0x8000
  s_addk_i32 s50, 256
  buffer_load_dwordx4 v33, s[40:43], s50 offen  lds
  s_add_u32 m0, m0, 0x8000
  s_addk_i32 s50, 256
  buffer_load_dwordx4 v33, s[40:43], s50 offen  lds
  s_add_u32 m0, m0, 0x8000
  s_addk_i32 s50, 256
  buffer_load_dwordx4 v33, s[40:43], s50 offen  lds
  s_add_u32 s63, s63, 1
  s_and_b32 s63, s63, 31
  s_sub_u32 s36, s36, 4
  s_cmp_ge_u32 s48, 26
  s_cbranch_scc1 L_pq
  s_cmp_gt_u32 s36, 64
  s_cselect_b32 s50, 7, 7
  s_and_b32 s50, s36, s50
  s_cbranch_scc1 L_pd
  s_branch L_pl
L_pq:
  s_cmp_lg_u32 s36, 0
  s_cbranch_scc1 L_pd
L_pw:
  v_mov_b32 v12, 1
  s_waitcnt vmcnt(0)
  ds_write_b32 v41, v12 offset:24
  ds_read_b32 v63, v41 offset:20
  s_lshl_b32 s50, s33, 15
  s_add_u32 s50, s50, 16384
  v_lshrrev_b32 v33, 2, v1
  v_lshl_add_u32 v33, v2, 3, v33
  v_lshlrev_b32 v33, 8, v33
  v_and_b32 v24, 3, v0
  v_lshl_add_u32 v33, v24, 3, v33
  v_add_u32 v33, s50, v33
  ds_read_b64_tr_b16 v[128:129], v33 offset:0
  ds_read_b64_tr_b16 v[130:131], v33 offset:1024
  ds_read_b64_tr_b16 v[132:133], v33 offset:8192
  ds_read_b64_tr_b16 v[134:135], v33 offset:9216
  ds_read_b64_tr_b16 v[136:137], v33 offset:16384
  ds_read_b64_tr_b16 v[138:139], v33 offset:17408
  ds_read_b64_tr_b16 v[140:141], v33 offset:24576
  ds_read_b64_tr_b16 v[142:143], v33 offset:25600
  s_waitcnt lgkmcnt(0)
  ds_read_b64_tr_b16 v[144:145], v33 offset:32
  ds_read_b64_tr_b16 v[146:147], v33 offset:1056
  ds_read_b64_tr_b16 v[148:149], v33 offset:8224
  ds_read_b64_tr_b16 v[150:151], v33 offset:9248
  ds_read_b64_tr_b16 v[152:153], v33 offset:16416
  ds_read_b64_tr_b16 v[154:155], v33 offset:17440
  ds_read_b64_tr_b16 v[156:157], v33 offset:24608
  ds_read_b64_tr_b16 v[158:159], v33 offset:25632
  s_waitcnt lgkmcnt(0)
  ds_read_b64_tr_b16 v[160:161], v33 offset:64
  ds_read_b64_tr_b16 v[162:163], v33 offset:1088
  ds_read_b64_tr_b16 v[164:165], v33 offset:8256
  ds_read_b64_tr_b16 v[166:167], v33 offset:9280
  ds_read_b64_tr_b16 v[168:169], v33 offset:16448
  ds_read_b64_tr_b16 v[170:171], v33 offset:17472
  ds_read_b64_tr_b16 v[172:173], v33 offset:24640
  ds_read_b64_tr_b16 v[174:175], v33 offset:25664
  s_waitcnt lgkmcnt(0)
  ds_read_b64_tr_b16 v[176:177], v33 offset:96
  ds_read_b64_tr_b16 v[178:179], v33 offset:1120
  ds_read_b64_tr_b16 v[180:181], v33 offset:8288
  ds_read_b64_tr_b16 v[182:183], v33 offset:9312
  ds_read_b64_tr_b16 v[184:185], v33 offset:16480
  ds_read_b64_tr_b16 v[186:187], v33 offset:17504
  ds_read_b64_tr_b16 v[188:189], v33 offset:24672
  ds_read_b64_tr_b16 v[190:191], v33 offset:25696
  s_waitcnt lgkmcnt(0)
  ds_read_b64_tr_b16 v[192:193], v33 offset:128
  ds_read_b64_tr_b16 v[194:195], v33 offset:1152
  ds_read_b64_tr_b16 v[196:197], v33 offset:8320
  ds_read_b64_tr_b16 v[198:199], v33 offset:9344
  ds_read_b64_tr_b16 v[200:201], v33 offset:16512
  ds_read_b64_tr_b16 v[202:203], v33 offset:17536
  ds_read_b64_tr_b16 v[204:205], v33 offset:24704
  ds_read_b64_tr_b16 v[206:207], v33 offset:25728
  s_waitcnt lgkmcnt(0)
  ds_read_b64_tr_b16 v[208:209], v33 offset:160
  ds_read_b64_tr_b16 v[210:211], v33 offset:1184
  ds_read_b64_tr_b16 v[212:213], v33 offset:8352
  ds_read_b64_tr_b16 v[214:215], v33 offset:9376
  ds_read_b64_tr_b16 v[216:217], v33 offset:16544
  ds_read_b64_tr_b16 v[218:219], v33 offset:17568
  ds_read_b64_tr_b16 v[220:221], v33 offset:24736
  ds_read_b64_tr_b16 v[222:223], v33 offset:25760
  s_waitcnt lgkmcnt(0)
  ds_read_b64_tr_b16 v[224:225], v33 offset:192
  ds_read_b64_tr_b16 v[226:227], v33 offset:1216
  ds_read_b64_tr_b16 v[228:229], v33 offset:8384
  ds_read_b64_tr_b16 v[230:231], v33 offset:9408
  ds_read_b64_tr_b16 v[232:233], v33 offset:16576
  ds_read_b64_tr_b16 v[234:235], v33 offset:17600
  ds_read_b64_tr_b16 v[236:237], v33 offset:24768
  ds_read_b64_tr_b16 v[238:239], v33 offset:25792
  s_waitcnt lgkmcnt(0)
  ds_read_b64_tr_b16 v[240:241], v33 offset:224
  ds_read_b64_tr_b16 v[242:243], v33 offset:1248
  ds_read_b64_tr_b16 v[244:245], v33 offset:8416
  ds_read_b64_tr_b16 v[246:247], v33 offset:9440
  ds_read_b64_tr_b16 v[248:249], v33 offset:16608
  ds_read_b64_tr_b16 v[250:251], v33 offset:17632
  ds_read_b64_tr_b16 v[252:253], v33 offset:24800
  ds_read_b64_tr_b16 v[254:255], v33 offset:25824
  s_waitcnt lgkmcnt(0)
  v_mov_b32 v12, 2
  ds_write_b32 v41, v12 offset:24
  s_mov_b32 s36, -1
L_pe:
  s_cmp_lt_u32 s48, 75
  s_cbranch_scc0 L_hfinal
  s_cmp_lt_i32 s79, 0
  s_cbranch_scc0 L_pl
  s_branch L_hfinal
L_last:
.section .rodata,"a"
.p2align 6
.amdhsa_kernel concat_heads__mha_block_cached__gqa_block_cached__decode_kernel
  .amdhsa_next_free_vgpr 256
  .amdhsa_next_free_sgpr 96
  .amdhsa_accum_offset 256
  .amdhsa_group_segment_fixed_size 0
  .amdhsa_kernarg_size 104
  .amdhsa_user_sgpr_count 2
  .amdhsa_user_sgpr_kernarg_segment_ptr 1
  .amdhsa_system_sgpr_workgroup_id_x 1
  .amdhsa_float_denorm_mode_32 3
.end_amdhsa_kernel
```
